```python
import torch

def _softmax(x, axis=-1):
    return torch.softmax(x, dim=axis)
def _gelu(x):
    return torch.nn.functional.gelu(x, approximate="tanh")
def _silu(x):
    return torch.nn.functional.silu(x)
def _sigmoid(x):
    return torch.sigmoid(x)
def _layernorm(x, axis=-1, eps=1e-5):
    m = x.mean(dim=axis, keepdim=True)
    v = x.var(dim=axis, keepdim=True, unbiased=False)
    return (x - m) / torch.sqrt(v + eps)
def _scatter_add(tgt, idx, src, axis=0):
    return tgt.clone().index_add_(axis, idx, src)
def _segment_sum(src, seg, n):
    out = torch.zeros((n,) + src.shape[1:], dtype=src.dtype)
    return out.index_add_(0, seg, src)
def _pad(x, pw):
    flat = tuple(v for pair in reversed(pw) for v in pair)
    return torch.nn.functional.pad(x, flat)

kernel_name = 'concat_heads__mha_block__sliding_block__prompt'

def setup_inputs():

    _w = (lambda a: (lambda t: t.to(torch.bfloat16) if t.is_floating_point() else t)(torch.as_tensor(a)))
    def _A_setup():
        B, S, D, H = 1, 2048, 576, 32
        return {
            "x": _w((lambda *s: torch.randn(*s, dtype=torch.bfloat16) * 0.2)(B, S, D)),
            "wqkv": _w((lambda *s: torch.randn(*s, dtype=torch.bfloat16) * 0.4)(D, 3 * D)),
            "wo": _w((lambda *s: torch.randn(*s, dtype=torch.bfloat16) * 0.1)(D, D)),
        }
    _A_in = _A_setup()

    def _B_setup():
        B, S, D = 1, 2048, 576
        return {
            "x": _w((lambda *s: torch.randn(*s, dtype=torch.bfloat16) * 0.4)(B, S, D)),
            "wqkv": _w((lambda *s: torch.randn(*s, dtype=torch.bfloat16) * 0.4)(D, 3 * D)),
            "wo": _w((lambda *s: torch.randn(*s, dtype=torch.bfloat16) * 0.05)(D, D)),
        }
    _B_in = _B_setup()

    return {
        "A_x": _A_in["x"],
        "A_wqkv": _A_in["wqkv"],
        "A_wo": _A_in["wo"],
        "B_x": _B_in["x"],
        "B_wqkv": _B_in["wqkv"],
        "B_wo": _B_in["wo"],
    }

def reference(A_x, A_wqkv, A_wo, B_x, B_wqkv, B_wo):
    def _A_ref(x, wqkv, wo):
        B, S, D = x.shape
        H = 32
        Dh = D // H
        qkv = (lambda x, *d: x.permute(*d))((x @ wqkv).reshape(B, S, 3, H, Dh), 2, 0, 3, 1, 4)
        q, k, v = qkv[0], qkv[1], qkv[2]
        scores = torch.einsum("bhqd,bhkd->bhqk", q, k) * (Dh ** -0.5)
        p = _softmax(scores, axis=-1)
        o = torch.einsum("bhqk,bhkd->bhqd", p, v)
        return (lambda x, *d: x.permute(*d))(o, 0, 2, 1, 3).reshape(B, S, D) @ wo

    def _B_ref(x, wqkv, wo):
        B, S, D = x.shape
        H = 32; Dh = D // H; W = 256
        qkv = (lambda x, *d: x.permute(*d))((x @ wqkv).reshape(B, S, 3, H, Dh), 2, 0, 3, 1, 4)
        q, k, v = qkv[0], qkv[1], qkv[2]
        scores = torch.einsum("bhqd,bhkd->bhqk", q, k) * (Dh ** -0.5)
        idx = torch.arange(S)
        mask = (idx[:, None] - idx[None, :] >= 0) & (idx[:, None] - idx[None, :] < W)
        scores = torch.where(mask[None, None], scores, -1e9)
        p = _softmax(scores, axis=-1)
        o = torch.einsum("bhqk,bhkd->bhqd", p, v)
        return (lambda x, *d: x.permute(*d))(o, 0, 2, 1, 3).reshape(B, S, D) @ wo

    a = _A_ref(A_x, A_wqkv, A_wo)
    b = _B_ref(B_x, B_wqkv, B_wo)
    return torch.concatenate([a, b], axis=-1)
```

```asm
; @launch kernel=qkv_kernel grid=(256,1,1) block=(512,1,1) lds=150528
; @launch kernel=attn_kernel grid=(256,1,1) block=(512,1,1) lds=163840
; @launch kernel=proj_kernel grid=(192,1,1) block=(512,1,1) lds=117248
.amdgcn_target "amdgcn-amd-amdhsa--gfx950"
.text
.globl qkv_kernel
.p2align 8
.type qkv_kernel,@function
qkv_kernel:
    s_cmp_ge_u32 s2, 256
    s_cbranch_scc1 K1_END
    s_load_dwordx4 s[24:27], s[0:1], 0
    s_load_dwordx4 s[28:31], s[0:1], 24
    s_load_dwordx2 s[32:33], s[0:1], 64
    v_lshrrev_b32 v1, 6, v0
    v_and_b32 v2, 63, v0
    s_and_b32 s16, s2, 1
    v_readfirstlane_b32 s19, v1
    s_lshr_b32 s3, s2, 1
    s_and_b32 s3, s3, 1
    s_lshl_b32 s3, s3, 3
    s_lshr_b32 s20, s2, 3
    s_and_b32 s17, s20, 7
    s_add_u32 s17, s17, s3
    s_lshr_b32 s3, s2, 2
    s_and_b32 s3, s3, 1
    s_lshl_b32 s3, s3, 2
    s_lshr_b32 s18, s20, 3
    s_add_u32 s18, s18, s3
    s_mul_i32 s44, s18, 432
    s_andn2_b32 s45, s44, 127
    s_sub_u32 s3, s44, s45
    s_cmp_gt_u32 s3, 80
    s_cselect_b32 s3, 64, 0
    s_add_u32 s45, s45, s3
    s_add_u32 s47, s44, 288
    s_add_u32 s46, s44, 144
    s_cmp_eq_u32 s18, 5
    s_cselect_b32 s46, s46, s44
    s_cselect_b32 s47, s44, s47
    s_waitcnt lgkmcnt(0)
    s_cmp_eq_u32 s16, 0
    s_cselect_b32 s4, s24, s28
    s_cselect_b32 s5, s25, s29
    s_mov_b32 s6, 2359296
    s_mov_b32 s7, 0x00020000
    s_cselect_b32 s8, s26, s30
    s_cselect_b32 s9, s27, s31
    s_mov_b32 s10, 1990656
    s_mov_b32 s11, 0x00020000
    s_cmp_ge_u32 s19, 4
    s_cbranch_scc1 K1_LOAD
    s_mul_i32 s3, s16, 7340032
    s_add_u32 s38, s32, s3
    s_addc_u32 s39, s33, 0
    s_mov_b32 s12, s38
    s_mov_b32 s13, s39
    s_mov_b32 s14, 7340032
    s_mov_b32 s15, 0x00020000
    v_and_b32 v3, 15, v2
    v_lshrrev_b32 v13, 4, v2
    v_bfe_u32 v14, v2, 2, 2
    v_and_b32 v15, 3, v2
    v_and_b32 v4, 7, v2
    v_xor_b32 v4, v4, v13
    v_lshlrev_b32 v4, 4, v4
    s_lshl_b32 s3, s19, 5
    v_add_u32 v5, s3, v3
    v_lshl_add_u32 v4, v5, 7, v4
    v_xor_b32 v5, 64, v4
    v_lshl_add_u32 v1, v13, 2, v14
    v_mul_u32_u24 v1, 1056, v1
    v_add_u32 v1, 16384, v1
    s_sub_u32 s20, s46, s45
    s_sub_u32 s21, s47, s45
    v_lshl_add_u32 v10, v15, 3, v1
    v_add_u32 v6, s20, v10
    v_add_u32 v7, s21, v10
    v_mul_u32_u24 v10, 72, v15
    v_add_u32 v10, v10, v1
    s_add_u32 s20, s20, 32
    v_add_u32 v10, s20, v10
    v_and_b32 v11, 1, v15
    v_mul_u32_u24 v11, 72, v11
    v_add_u32 v11, v11, v1
    s_add_u32 s21, s21, 32
    v_add_u32 v11, s21, v11
    v_mov_b32 v16, 0
    v_mov_b32 v17, 0
    v_mov_b32 v18, 0
    v_mov_b32 v19, 0
    s_nop 1
    v_mfma_f32_16x16x32_bf16 v[64:67], v[16:19], v[16:19], 0
    v_mfma_f32_16x16x32_bf16 v[68:71], v[16:19], v[16:19], 0
    v_mfma_f32_16x16x32_bf16 v[72:75], v[16:19], v[16:19], 0
    v_mfma_f32_16x16x32_bf16 v[76:79], v[16:19], v[16:19], 0
    v_mfma_f32_16x16x32_bf16 v[80:83], v[16:19], v[16:19], 0
    v_mfma_f32_16x16x32_bf16 v[84:87], v[16:19], v[16:19], 0
    v_mfma_f32_16x16x32_bf16 v[88:91], v[16:19], v[16:19], 0
    v_mfma_f32_16x16x32_bf16 v[92:95], v[16:19], v[16:19], 0
    v_mfma_f32_16x16x32_bf16 v[96:99], v[16:19], v[16:19], 0
    v_mfma_f32_16x16x32_bf16 v[100:103], v[16:19], v[16:19], 0
    v_mfma_f32_16x16x32_bf16 v[104:107], v[16:19], v[16:19], 0
    v_mfma_f32_16x16x32_bf16 v[108:111], v[16:19], v[16:19], 0
    v_mfma_f32_16x16x32_bf16 v[112:115], v[16:19], v[16:19], 0
    v_mfma_f32_16x16x32_bf16 v[116:119], v[16:19], v[16:19], 0
    v_mfma_f32_16x16x32_bf16 v[120:123], v[16:19], v[16:19], 0
    v_mfma_f32_16x16x32_bf16 v[124:127], v[16:19], v[16:19], 0
    v_mfma_f32_16x16x32_bf16 v[128:131], v[16:19], v[16:19], 0
    v_mfma_f32_16x16x32_bf16 v[132:135], v[16:19], v[16:19], 0
    v_mfma_f32_16x16x32_bf16 v[136:139], v[16:19], v[16:19], 0
    v_mfma_f32_16x16x32_bf16 v[140:143], v[16:19], v[16:19], 0
    v_mfma_f32_16x16x32_bf16 v[144:147], v[16:19], v[16:19], 0
    v_mfma_f32_16x16x32_bf16 v[148:151], v[16:19], v[16:19], 0
    v_mfma_f32_16x16x32_bf16 v[152:155], v[16:19], v[16:19], 0
    v_mfma_f32_16x16x32_bf16 v[156:159], v[16:19], v[16:19], 0
    v_mfma_f32_16x16x32_bf16 v[160:163], v[16:19], v[16:19], 0
    v_mfma_f32_16x16x32_bf16 v[164:167], v[16:19], v[16:19], 0
    v_mfma_f32_16x16x32_bf16 v[168:171], v[16:19], v[16:19], 0
    v_mfma_f32_16x16x32_bf16 v[172:175], v[16:19], v[16:19], 0
    s_cmp_ge_u32 s46, 2304
    s_cselect_b32 s3, 2304, 0
    s_sub_u32 s26, s46, s3
    s_cmp_ge_u32 s26, 1152
    s_cselect_b32 s3, 1152, 0
    s_sub_u32 s26, s26, s3
    s_mul_i32 s26, s26, 1821
    s_lshr_b32 s26, s26, 16
    s_mul_i32 s26, s26, 229376
    s_cmp_ge_u32 s47, 2304
    s_cselect_b32 s3, 2304, 0
    s_sub_u32 s27, s47, s3
    s_cmp_ge_u32 s27, 1152
    s_cselect_b32 s3, 1152, 0
    s_sub_u32 s27, s27, s3
    s_mul_i32 s27, s27, 1821
    s_lshr_b32 s27, s27, 16
    s_mul_i32 s27, s27, 229376
    s_lshl_b32 s23, s17, 2
    s_add_u32 s23, s23, s19
    s_lshl_b32 s24, s23, 5
    s_mul_i32 s25, s23, 1152
    s_add_u32 s25, s25, 155648
    s_lshl_b32 s21, s23, 10
    s_mov_b32 s22, 0x3eae1a93
    s_mov_b32 s23, s22
    v_lshlrev_b32 v12, 4, v2
    v_lshrrev_b32 v14, 4, v2
    v_and_b32 v15, 1, v14
    v_mul_u32_u24 v8, 576, v15
    v_lshrrev_b32 v15, 1, v14
    v_mul_u32_u24 v15, 288, v15
    v_add_u32 v8, v8, v15
    v_lshrrev_b32 v15, 1, v3
    s_mov_b32 s3, 229376
    v_mul_lo_u32 v15, v15, s3
    v_add_u32 v9, v8, v15
    v_and_b32 v15, 1, v3
    v_lshl_add_u32 v9, v15, 4, v9
    v_bfe_u32 v15, v3, 1, 1
    v_xor_b32 v15, 1, v15
    v_lshl_add_u32 v9, v15, 8, v9
    v_mov_b32 v15, 0x40000000
    v_cmp_gt_u32 vcc, 8, v3
    v_lshl_add_u32 v8, v3, 4, v8
    s_mov_b32 s3, 458752
    v_cndmask_b32 v176, v15, v9, vcc
    v_mul_lo_u32 v13, v14, s3
    s_mov_b32 s48, 0
    s_mov_b32 s50, 50176
    s_mov_b32 s55, 0x124
    s_mov_b32 s56, 4294866944
    s_mov_b32 s57, 50176
    s_barrier
    ds_read_b128 v[16:19], v4 offset:0
    ds_read_b128 v[20:23], v4 offset:2048
    ds_read_b64_tr_b16 v[32:33], v6 offset:0
    ds_read_b64_tr_b16 v[34:35], v6 offset:512
    ds_read_b64_tr_b16 v[36:37], v6 offset:40
    ds_read_b64_tr_b16 v[38:39], v6 offset:552
    ds_read_b64_tr_b16 v[40:41], v6 offset:72
    ds_read_b64_tr_b16 v[42:43], v6 offset:584
    ds_read_b64_tr_b16 v[44:45], v6 offset:112
    ds_read_b64_tr_b16 v[46:47], v6 offset:624
    ds_read_b64_tr_b16 v[48:49], v6 offset:144
    ds_read_b64_tr_b16 v[50:51], v6 offset:656
    s_waitcnt lgkmcnt(0)
    s_cmp_ge_u32 s18, 6
    s_cbranch_scc1 K1_LSS
    s_cmp_eq_u32 s18, 5
    s_cbranch_scc1 K1_LSN
K1_LNN:
    s_waitcnt lgkmcnt(2)
    v_mfma_f32_16x16x32_bf16 v[64:67], v[32:35], v[16:19], v[64:67]
    ds_read_b64_tr_b16 v[52:53], v6 offset:184
    v_mfma_f32_16x16x32_bf16 v[68:71], v[32:35], v[20:23], v[68:71]
    ds_read_b64_tr_b16 v[54:55], v6 offset:696
    s_waitcnt lgkmcnt(4)
    v_mfma_f32_16x16x32_bf16 v[72:75], v[36:39], v[16:19], v[72:75]
    ds_read_b64_tr_b16 v[56:57], v6 offset:216
    v_mfma_f32_16x16x32_bf16 v[76:79], v[36:39], v[20:23], v[76:79]
    ds_read_b64_tr_b16 v[58:59], v6 offset:728
    s_waitcnt lgkmcnt(6)
    v_mfma_f32_16x16x32_bf16 v[80:83], v[40:43], v[16:19], v[80:83]
    ds_read_b64_tr_b16 v[32:33], v6 offset:256
    ds_read_b64_tr_b16 v[34:35], v6 offset:768
    v_mfma_f32_16x16x32_bf16 v[84:87], v[40:43], v[20:23], v[84:87]
    ds_read_b128 v[24:27], v5 offset:0
    ds_read_b128 v[28:31], v5 offset:2048
    s_waitcnt lgkmcnt(10)
    v_mfma_f32_16x16x32_bf16 v[88:91], v[44:47], v[16:19], v[88:91]
    ds_read_b64_tr_b16 v[36:37], v7 offset:0
    v_mfma_f32_16x16x32_bf16 v[92:95], v[44:47], v[20:23], v[92:95]
    ds_read_b64_tr_b16 v[38:39], v7 offset:512
    s_waitcnt lgkmcnt(10)
    v_mfma_f32_16x16x32_bf16 v[96:99], v[48:51], v[16:19], v[96:99]
    ds_read_b64_tr_b16 v[40:41], v7 offset:40
    v_mfma_f32_16x16x32_bf16 v[100:103], v[48:51], v[20:23], v[100:103]
    ds_read_b64_tr_b16 v[42:43], v7 offset:552
    s_waitcnt lgkmcnt(10)
    v_mfma_f32_16x16x32_bf16 v[104:107], v[52:55], v[16:19], v[104:107]
    ds_read_b64_tr_b16 v[44:45], v7 offset:72
    v_mfma_f32_16x16x32_bf16 v[108:111], v[52:55], v[20:23], v[108:111]
    ds_read_b64_tr_b16 v[46:47], v7 offset:584
    s_waitcnt lgkmcnt(10)
    v_mfma_f32_16x16x32_bf16 v[112:115], v[56:59], v[16:19], v[112:115]
    ds_read_b64_tr_b16 v[48:49], v7 offset:112
    v_mfma_f32_16x16x32_bf16 v[116:119], v[56:59], v[20:23], v[116:119]
    ds_read_b64_tr_b16 v[50:51], v7 offset:624
    s_waitcnt lgkmcnt(10)
    v_mfma_f32_16x16x32_bf16 v[120:123], v[32:35], v[16:19], v[120:123]
    ds_read_b64_tr_b16 v[52:53], v10 offset:0
    v_mfma_f32_16x16x32_bf16 v[124:127], v[32:35], v[20:23], v[124:127]
    ds_read_b64_tr_b16 v[54:55], v10 offset:512
    s_waitcnt lgkmcnt(8)
    v_mfma_f32_16x16x32_bf16 v[128:131], v[36:39], v[16:19], v[128:131]
    ds_read_b64_tr_b16 v[56:57], v11 offset:0
    v_mfma_f32_16x16x32_bf16 v[132:135], v[36:39], v[20:23], v[132:135]
    ds_read_b64_tr_b16 v[58:59], v11 offset:512
    s_waitcnt lgkmcnt(8)
    v_mfma_f32_16x16x32_bf16 v[136:139], v[40:43], v[16:19], v[136:139]
    ds_read_b64_tr_b16 v[32:33], v6 offset:16896
    v_mfma_f32_16x16x32_bf16 v[140:143], v[40:43], v[20:23], v[140:143]
    ds_read_b64_tr_b16 v[34:35], v6 offset:17408
    s_waitcnt lgkmcnt(8)
    v_mfma_f32_16x16x32_bf16 v[144:147], v[44:47], v[16:19], v[144:147]
    ds_read_b64_tr_b16 v[36:37], v6 offset:16936
    v_mfma_f32_16x16x32_bf16 v[148:151], v[44:47], v[20:23], v[148:151]
    ds_read_b64_tr_b16 v[38:39], v6 offset:17448
    s_waitcnt lgkmcnt(8)
    v_mfma_f32_16x16x32_bf16 v[152:155], v[48:51], v[16:19], v[152:155]
    ds_read_b64_tr_b16 v[40:41], v6 offset:16968
    v_mfma_f32_16x16x32_bf16 v[156:159], v[48:51], v[20:23], v[156:159]
    ds_read_b64_tr_b16 v[42:43], v6 offset:17480
    s_waitcnt lgkmcnt(8)
    v_mfma_f32_16x16x32_bf16 v[160:163], v[52:55], v[16:19], v[160:163]
    ds_read_b64_tr_b16 v[44:45], v6 offset:17008
    v_mfma_f32_16x16x32_bf16 v[164:167], v[52:55], v[20:23], v[164:167]
    ds_read_b64_tr_b16 v[46:47], v6 offset:17520
    s_waitcnt lgkmcnt(8)
    v_mfma_f32_16x16x32_bf16 v[168:171], v[56:59], v[16:19], v[168:171]
    ds_read_b64_tr_b16 v[48:49], v6 offset:17040
    v_mfma_f32_16x16x32_bf16 v[172:175], v[56:59], v[20:23], v[172:175]
    ds_read_b64_tr_b16 v[50:51], v6 offset:17552
    s_waitcnt lgkmcnt(8)
    v_mfma_f32_16x16x32_bf16 v[64:67], v[32:35], v[24:27], v[64:67]
    ds_read_b64_tr_b16 v[52:53], v6 offset:17080
    v_mfma_f32_16x16x32_bf16 v[68:71], v[32:35], v[28:31], v[68:71]
    ds_read_b64_tr_b16 v[54:55], v6 offset:17592
    s_waitcnt lgkmcnt(8)
    v_mfma_f32_16x16x32_bf16 v[72:75], v[36:39], v[24:27], v[72:75]
    ds_read_b64_tr_b16 v[56:57], v6 offset:17112
    v_mfma_f32_16x16x32_bf16 v[76:79], v[36:39], v[28:31], v[76:79]
    ds_read_b64_tr_b16 v[58:59], v6 offset:17624
    s_waitcnt lgkmcnt(8)
    v_mfma_f32_16x16x32_bf16 v[80:83], v[40:43], v[24:27], v[80:83]
    ds_read_b64_tr_b16 v[32:33], v6 offset:17152
    v_mfma_f32_16x16x32_bf16 v[84:87], v[40:43], v[28:31], v[84:87]
    ds_read_b64_tr_b16 v[34:35], v6 offset:17664
    s_waitcnt lgkmcnt(8)
    v_mfma_f32_16x16x32_bf16 v[88:91], v[44:47], v[24:27], v[88:91]
    ds_read_b64_tr_b16 v[36:37], v7 offset:16896
    v_mfma_f32_16x16x32_bf16 v[92:95], v[44:47], v[28:31], v[92:95]
    ds_read_b64_tr_b16 v[38:39], v7 offset:17408
    s_waitcnt lgkmcnt(8)
    v_mfma_f32_16x16x32_bf16 v[96:99], v[48:51], v[24:27], v[96:99]
    ds_read_b64_tr_b16 v[40:41], v7 offset:16936
    v_mfma_f32_16x16x32_bf16 v[100:103], v[48:51], v[28:31], v[100:103]
    ds_read_b64_tr_b16 v[42:43], v7 offset:17448
    s_waitcnt lgkmcnt(8)
    v_mfma_f32_16x16x32_bf16 v[104:107], v[52:55], v[24:27], v[104:107]
    ds_read_b64_tr_b16 v[44:45], v7 offset:16968
    v_mfma_f32_16x16x32_bf16 v[108:111], v[52:55], v[28:31], v[108:111]
    ds_read_b64_tr_b16 v[46:47], v7 offset:17480
    s_waitcnt lgkmcnt(8)
    v_mfma_f32_16x16x32_bf16 v[112:115], v[56:59], v[24:27], v[112:115]
    ds_read_b64_tr_b16 v[48:49], v7 offset:17008
    v_mfma_f32_16x16x32_bf16 v[116:119], v[56:59], v[28:31], v[116:119]
    ds_read_b64_tr_b16 v[50:51], v7 offset:17520
    s_waitcnt lgkmcnt(8)
    v_mfma_f32_16x16x32_bf16 v[120:123], v[32:35], v[24:27], v[120:123]
    ds_read_b64_tr_b16 v[52:53], v10 offset:16896
    v_mfma_f32_16x16x32_bf16 v[124:127], v[32:35], v[28:31], v[124:127]
    ds_read_b64_tr_b16 v[54:55], v10 offset:17408
    s_waitcnt lgkmcnt(8)
    v_mfma_f32_16x16x32_bf16 v[128:131], v[36:39], v[24:27], v[128:131]
    ds_read_b64_tr_b16 v[56:57], v11 offset:16896
    v_mfma_f32_16x16x32_bf16 v[132:135], v[36:39], v[28:31], v[132:135]
    ds_read_b64_tr_b16 v[58:59], v11 offset:17408
    s_waitcnt lgkmcnt(8)
    v_mfma_f32_16x16x32_bf16 v[136:139], v[40:43], v[24:27], v[136:139]
    v_mfma_f32_16x16x32_bf16 v[140:143], v[40:43], v[28:31], v[140:143]
    s_waitcnt lgkmcnt(6)
    v_mfma_f32_16x16x32_bf16 v[144:147], v[44:47], v[24:27], v[144:147]
    v_mfma_f32_16x16x32_bf16 v[148:151], v[44:47], v[28:31], v[148:151]
    s_waitcnt lgkmcnt(0)
    s_barrier
    v_add_u32 v4, s50, v4
    v_add_u32 v10, s50, v10
    v_add_u32 v11, s50, v11
    v_add_u32 v6, s50, v6
    v_add_u32 v7, s50, v7
    ds_read_b64_tr_b16 v[32:33], v6 offset:0
    ds_read_b64_tr_b16 v[34:35], v6 offset:512
    ds_read_b64_tr_b16 v[36:37], v6 offset:40
    ds_read_b64_tr_b16 v[38:39], v6 offset:552
    v_mfma_f32_16x16x32_bf16 v[152:155], v[48:51], v[24:27], v[152:155]
    ds_read_b64_tr_b16 v[40:41], v6 offset:72
    ds_read_b64_tr_b16 v[42:43], v6 offset:584
    ds_read_b64_tr_b16 v[44:45], v6 offset:112
    v_mfma_f32_16x16x32_bf16 v[156:159], v[48:51], v[28:31], v[156:159]
    ds_read_b64_tr_b16 v[46:47], v6 offset:624
    ds_read_b128 v[16:19], v4 offset:0
    ds_read_b128 v[20:23], v4 offset:2048
    v_mfma_f32_16x16x32_bf16 v[160:163], v[52:55], v[24:27], v[160:163]
    ds_read_b64_tr_b16 v[48:49], v6 offset:144
    v_mfma_f32_16x16x32_bf16 v[164:167], v[52:55], v[28:31], v[164:167]
    v_add_u32 v5, s50, v5
    ds_read_b64_tr_b16 v[50:51], v6 offset:656
    v_mfma_f32_16x16x32_bf16 v[168:171], v[56:59], v[24:27], v[168:171]
    v_mfma_f32_16x16x32_bf16 v[172:175], v[56:59], v[28:31], v[172:175]
    s_add_u32 s48, s48, 1
    s_bitcmp1_b32 s55, s48
    s_cselect_b32 s50, s56, s57
    s_cmp_lt_u32 s48, 8
    s_cbranch_scc1 K1_LNN
    s_cmp_lt_u32 s18, 2
    s_cbranch_scc1 K1_EQQ
    s_cmp_eq_u32 s18, 2
    s_cbranch_scc1 K1_EQK
    s_branch K1_EKK
K1_LSN:
    s_waitcnt lgkmcnt(2)
    v_mfma_f32_16x16x32_bf16 v[64:67], v[16:19], v[32:35], v[64:67]
    ds_read_b64_tr_b16 v[52:53], v6 offset:184
    v_mfma_f32_16x16x32_bf16 v[68:71], v[20:23], v[32:35], v[68:71]
    ds_read_b64_tr_b16 v[54:55], v6 offset:696
    s_waitcnt lgkmcnt(4)
    v_mfma_f32_16x16x32_bf16 v[72:75], v[16:19], v[36:39], v[72:75]
    ds_read_b64_tr_b16 v[56:57], v6 offset:216
    v_mfma_f32_16x16x32_bf16 v[76:79], v[20:23], v[36:39], v[76:79]
    ds_read_b64_tr_b16 v[58:59], v6 offset:728
    s_waitcnt lgkmcnt(6)
    v_mfma_f32_16x16x32_bf16 v[80:83], v[16:19], v[40:43], v[80:83]
    ds_read_b64_tr_b16 v[32:33], v6 offset:256
    ds_read_b64_tr_b16 v[34:35], v6 offset:768
    v_mfma_f32_16x16x32_bf16 v[84:87], v[20:23], v[40:43], v[84:87]
    ds_read_b128 v[24:27], v5 offset:0
    ds_read_b128 v[28:31], v5 offset:2048
    s_waitcnt lgkmcnt(10)
    v_mfma_f32_16x16x32_bf16 v[88:91], v[16:19], v[44:47], v[88:91]
    ds_read_b64_tr_b16 v[36:37], v7 offset:0
    v_mfma_f32_16x16x32_bf16 v[92:95], v[20:23], v[44:47], v[92:95]
    ds_read_b64_tr_b16 v[38:39], v7 offset:512
    s_waitcnt lgkmcnt(10)
    v_mfma_f32_16x16x32_bf16 v[96:99], v[16:19], v[48:51], v[96:99]
    ds_read_b64_tr_b16 v[40:41], v7 offset:40
    v_mfma_f32_16x16x32_bf16 v[100:103], v[20:23], v[48:51], v[100:103]
    ds_read_b64_tr_b16 v[42:43], v7 offset:552
    s_waitcnt lgkmcnt(10)
    v_mfma_f32_16x16x32_bf16 v[104:107], v[16:19], v[52:55], v[104:107]
    ds_read_b64_tr_b16 v[44:45], v7 offset:72
    v_mfma_f32_16x16x32_bf16 v[108:111], v[20:23], v[52:55], v[108:111]
    ds_read_b64_tr_b16 v[46:47], v7 offset:584
    s_waitcnt lgkmcnt(10)
    v_mfma_f32_16x16x32_bf16 v[112:115], v[16:19], v[56:59], v[112:115]
    ds_read_b64_tr_b16 v[48:49], v7 offset:112
    v_mfma_f32_16x16x32_bf16 v[116:119], v[20:23], v[56:59], v[116:119]
    ds_read_b64_tr_b16 v[50:51], v7 offset:624
    s_waitcnt lgkmcnt(10)
    v_mfma_f32_16x16x32_bf16 v[120:123], v[16:19], v[32:35], v[120:123]
    ds_read_b64_tr_b16 v[52:53], v10 offset:0
    v_mfma_f32_16x16x32_bf16 v[124:127], v[20:23], v[32:35], v[124:127]
    ds_read_b64_tr_b16 v[54:55], v10 offset:512
    s_waitcnt lgkmcnt(8)
    v_mfma_f32_16x16x32_bf16 v[128:131], v[36:39], v[16:19], v[128:131]
    ds_read_b64_tr_b16 v[56:57], v11 offset:0
    v_mfma_f32_16x16x32_bf16 v[132:135], v[36:39], v[20:23], v[132:135]
    ds_read_b64_tr_b16 v[58:59], v11 offset:512
    s_waitcnt lgkmcnt(8)
    v_mfma_f32_16x16x32_bf16 v[136:139], v[40:43], v[16:19], v[136:139]
    ds_read_b64_tr_b16 v[32:33], v6 offset:16896
    v_mfma_f32_16x16x32_bf16 v[140:143], v[40:43], v[20:23], v[140:143]
    ds_read_b64_tr_b16 v[34:35], v6 offset:17408
    s_waitcnt lgkmcnt(8)
    v_mfma_f32_16x16x32_bf16 v[144:147], v[44:47], v[16:19], v[144:147]
    ds_read_b64_tr_b16 v[36:37], v6 offset:16936
    v_mfma_f32_16x16x32_bf16 v[148:151], v[44:47], v[20:23], v[148:151]
    ds_read_b64_tr_b16 v[38:39], v6 offset:17448
    s_waitcnt lgkmcnt(8)
    v_mfma_f32_16x16x32_bf16 v[152:155], v[48:51], v[16:19], v[152:155]
    ds_read_b64_tr_b16 v[40:41], v6 offset:16968
    v_mfma_f32_16x16x32_bf16 v[156:159], v[48:51], v[20:23], v[156:159]
    ds_read_b64_tr_b16 v[42:43], v6 offset:17480
    s_waitcnt lgkmcnt(8)
    v_mfma_f32_16x16x32_bf16 v[160:163], v[16:19], v[52:55], v[160:163]
    ds_read_b64_tr_b16 v[44:45], v6 offset:17008
    v_mfma_f32_16x16x32_bf16 v[164:167], v[20:23], v[52:55], v[164:167]
    ds_read_b64_tr_b16 v[46:47], v6 offset:17520
    s_waitcnt lgkmcnt(8)
    v_mfma_f32_16x16x32_bf16 v[168:171], v[56:59], v[16:19], v[168:171]
    ds_read_b64_tr_b16 v[48:49], v6 offset:17040
    v_mfma_f32_16x16x32_bf16 v[172:175], v[56:59], v[20:23], v[172:175]
    ds_read_b64_tr_b16 v[50:51], v6 offset:17552
    s_waitcnt lgkmcnt(8)
    v_mfma_f32_16x16x32_bf16 v[64:67], v[24:27], v[32:35], v[64:67]
    ds_read_b64_tr_b16 v[52:53], v6 offset:17080
    v_mfma_f32_16x16x32_bf16 v[68:71], v[28:31], v[32:35], v[68:71]
    ds_read_b64_tr_b16 v[54:55], v6 offset:17592
    s_waitcnt lgkmcnt(8)
    v_mfma_f32_16x16x32_bf16 v[72:75], v[24:27], v[36:39], v[72:75]
    ds_read_b64_tr_b16 v[56:57], v6 offset:17112
    v_mfma_f32_16x16x32_bf16 v[76:79], v[28:31], v[36:39], v[76:79]
    ds_read_b64_tr_b16 v[58:59], v6 offset:17624
    s_waitcnt lgkmcnt(8)
    v_mfma_f32_16x16x32_bf16 v[80:83], v[24:27], v[40:43], v[80:83]
    ds_read_b64_tr_b16 v[32:33], v6 offset:17152
    v_mfma_f32_16x16x32_bf16 v[84:87], v[28:31], v[40:43], v[84:87]
    ds_read_b64_tr_b16 v[34:35], v6 offset:17664
    s_waitcnt lgkmcnt(8)
    v_mfma_f32_16x16x32_bf16 v[88:91], v[24:27], v[44:47], v[88:91]
    ds_read_b64_tr_b16 v[36:37], v7 offset:16896
    v_mfma_f32_16x16x32_bf16 v[92:95], v[28:31], v[44:47], v[92:95]
    ds_read_b64_tr_b16 v[38:39], v7 offset:17408
    s_waitcnt lgkmcnt(8)
    v_mfma_f32_16x16x32_bf16 v[96:99], v[24:27], v[48:51], v[96:99]
    ds_read_b64_tr_b16 v[40:41], v7 offset:16936
    v_mfma_f32_16x16x32_bf16 v[100:103], v[28:31], v[48:51], v[100:103]
    ds_read_b64_tr_b16 v[42:43], v7 offset:17448
    s_waitcnt lgkmcnt(8)
    v_mfma_f32_16x16x32_bf16 v[104:107], v[24:27], v[52:55], v[104:107]
    ds_read_b64_tr_b16 v[44:45], v7 offset:16968
    v_mfma_f32_16x16x32_bf16 v[108:111], v[28:31], v[52:55], v[108:111]
    ds_read_b64_tr_b16 v[46:47], v7 offset:17480
    s_waitcnt lgkmcnt(8)
    v_mfma_f32_16x16x32_bf16 v[112:115], v[24:27], v[56:59], v[112:115]
    ds_read_b64_tr_b16 v[48:49], v7 offset:17008
    v_mfma_f32_16x16x32_bf16 v[116:119], v[28:31], v[56:59], v[116:119]
    ds_read_b64_tr_b16 v[50:51], v7 offset:17520
    s_waitcnt lgkmcnt(8)
    v_mfma_f32_16x16x32_bf16 v[120:123], v[24:27], v[32:35], v[120:123]
    ds_read_b64_tr_b16 v[52:53], v10 offset:16896
    v_mfma_f32_16x16x32_bf16 v[124:127], v[28:31], v[32:35], v[124:127]
    ds_read_b64_tr_b16 v[54:55], v10 offset:17408
    s_waitcnt lgkmcnt(8)
    v_mfma_f32_16x16x32_bf16 v[128:131], v[36:39], v[24:27], v[128:131]
    ds_read_b64_tr_b16 v[56:57], v11 offset:16896
    v_mfma_f32_16x16x32_bf16 v[132:135], v[36:39], v[28:31], v[132:135]
    ds_read_b64_tr_b16 v[58:59], v11 offset:17408
    s_waitcnt lgkmcnt(8)
    v_mfma_f32_16x16x32_bf16 v[136:139], v[40:43], v[24:27], v[136:139]
    v_mfma_f32_16x16x32_bf16 v[140:143], v[40:43], v[28:31], v[140:143]
    s_waitcnt lgkmcnt(6)
    v_mfma_f32_16x16x32_bf16 v[144:147], v[44:47], v[24:27], v[144:147]
    v_mfma_f32_16x16x32_bf16 v[148:151], v[44:47], v[28:31], v[148:151]
    s_waitcnt lgkmcnt(0)
    s_barrier
    v_add_u32 v4, s50, v4
    v_add_u32 v10, s50, v10
    v_add_u32 v11, s50, v11
    v_add_u32 v6, s50, v6
    v_add_u32 v7, s50, v7
    ds_read_b64_tr_b16 v[32:33], v6 offset:0
    ds_read_b64_tr_b16 v[34:35], v6 offset:512
    ds_read_b64_tr_b16 v[36:37], v6 offset:40
    ds_read_b64_tr_b16 v[38:39], v6 offset:552
    v_mfma_f32_16x16x32_bf16 v[152:155], v[48:51], v[24:27], v[152:155]
    ds_read_b64_tr_b16 v[40:41], v6 offset:72
    ds_read_b64_tr_b16 v[42:43], v6 offset:584
    ds_read_b64_tr_b16 v[44:45], v6 offset:112
    v_mfma_f32_16x16x32_bf16 v[156:159], v[48:51], v[28:31], v[156:159]
    ds_read_b64_tr_b16 v[46:47], v6 offset:624
    ds_read_b128 v[16:19], v4 offset:0
    ds_read_b128 v[20:23], v4 offset:2048
    v_mfma_f32_16x16x32_bf16 v[160:163], v[24:27], v[52:55], v[160:163]
    ds_read_b64_tr_b16 v[48:49], v6 offset:144
    v_mfma_f32_16x16x32_bf16 v[164:167], v[28:31], v[52:55], v[164:167]
    v_add_u32 v5, s50, v5
    ds_read_b64_tr_b16 v[50:51], v6 offset:656
    v_mfma_f32_16x16x32_bf16 v[168:171], v[56:59], v[24:27], v[168:171]
    v_mfma_f32_16x16x32_bf16 v[172:175], v[56:59], v[28:31], v[172:175]
    s_add_u32 s48, s48, 1
    s_bitcmp1_b32 s55, s48
    s_cselect_b32 s50, s56, s57
    s_cmp_lt_u32 s48, 8
    s_cbranch_scc1 K1_LSN
    s_branch K1_EVK
K1_LSS:
    s_waitcnt lgkmcnt(2)
    v_mfma_f32_16x16x32_bf16 v[64:67], v[16:19], v[32:35], v[64:67]
    ds_read_b64_tr_b16 v[52:53], v6 offset:184
    v_mfma_f32_16x16x32_bf16 v[68:71], v[20:23], v[32:35], v[68:71]
    ds_read_b64_tr_b16 v[54:55], v6 offset:696
    s_waitcnt lgkmcnt(4)
    v_mfma_f32_16x16x32_bf16 v[72:75], v[16:19], v[36:39], v[72:75]
    ds_read_b64_tr_b16 v[56:57], v6 offset:216
    v_mfma_f32_16x16x32_bf16 v[76:79], v[20:23], v[36:39], v[76:79]
    ds_read_b64_tr_b16 v[58:59], v6 offset:728
    s_waitcnt lgkmcnt(6)
    v_mfma_f32_16x16x32_bf16 v[80:83], v[16:19], v[40:43], v[80:83]
    ds_read_b64_tr_b16 v[32:33], v6 offset:256
    ds_read_b64_tr_b16 v[34:35], v6 offset:768
    v_mfma_f32_16x16x32_bf16 v[84:87], v[20:23], v[40:43], v[84:87]
    ds_read_b128 v[24:27], v5 offset:0
    ds_read_b128 v[28:31], v5 offset:2048
    s_waitcnt lgkmcnt(10)
    v_mfma_f32_16x16x32_bf16 v[88:91], v[16:19], v[44:47], v[88:91]
    ds_read_b64_tr_b16 v[36:37], v7 offset:0
    v_mfma_f32_16x16x32_bf16 v[92:95], v[20:23], v[44:47], v[92:95]
    ds_read_b64_tr_b16 v[38:39], v7 offset:512
    s_waitcnt lgkmcnt(10)
    v_mfma_f32_16x16x32_bf16 v[96:99], v[16:19], v[48:51], v[96:99]
    ds_read_b64_tr_b16 v[40:41], v7 offset:40
    v_mfma_f32_16x16x32_bf16 v[100:103], v[20:23], v[48:51], v[100:103]
    ds_read_b64_tr_b16 v[42:43], v7 offset:552
    s_waitcnt lgkmcnt(10)
    v_mfma_f32_16x16x32_bf16 v[104:107], v[16:19], v[52:55], v[104:107]
    ds_read_b64_tr_b16 v[44:45], v7 offset:72
    v_mfma_f32_16x16x32_bf16 v[108:111], v[20:23], v[52:55], v[108:111]
    ds_read_b64_tr_b16 v[46:47], v7 offset:584
    s_waitcnt lgkmcnt(10)
    v_mfma_f32_16x16x32_bf16 v[112:115], v[16:19], v[56:59], v[112:115]
    ds_read_b64_tr_b16 v[48:49], v7 offset:112
    v_mfma_f32_16x16x32_bf16 v[116:119], v[20:23], v[56:59], v[116:119]
    ds_read_b64_tr_b16 v[50:51], v7 offset:624
    s_waitcnt lgkmcnt(10)
    v_mfma_f32_16x16x32_bf16 v[120:123], v[16:19], v[32:35], v[120:123]
    ds_read_b64_tr_b16 v[52:53], v10 offset:0
    v_mfma_f32_16x16x32_bf16 v[124:127], v[20:23], v[32:35], v[124:127]
    ds_read_b64_tr_b16 v[54:55], v10 offset:512
    s_waitcnt lgkmcnt(8)
    v_mfma_f32_16x16x32_bf16 v[128:131], v[16:19], v[36:39], v[128:131]
    ds_read_b64_tr_b16 v[56:57], v11 offset:0
    v_mfma_f32_16x16x32_bf16 v[132:135], v[20:23], v[36:39], v[132:135]
    ds_read_b64_tr_b16 v[58:59], v11 offset:512
    s_waitcnt lgkmcnt(8)
    v_mfma_f32_16x16x32_bf16 v[136:139], v[16:19], v[40:43], v[136:139]
    ds_read_b64_tr_b16 v[32:33], v6 offset:16896
    v_mfma_f32_16x16x32_bf16 v[140:143], v[20:23], v[40:43], v[140:143]
    ds_read_b64_tr_b16 v[34:35], v6 offset:17408
    s_waitcnt lgkmcnt(8)
    v_mfma_f32_16x16x32_bf16 v[144:147], v[16:19], v[44:47], v[144:147]
    ds_read_b64_tr_b16 v[36:37], v6 offset:16936
    v_mfma_f32_16x16x32_bf16 v[148:151], v[20:23], v[44:47], v[148:151]
    ds_read_b64_tr_b16 v[38:39], v6 offset:17448
    s_waitcnt lgkmcnt(8)
    v_mfma_f32_16x16x32_bf16 v[152:155], v[16:19], v[48:51], v[152:155]
    ds_read_b64_tr_b16 v[40:41], v6 offset:16968
    v_mfma_f32_16x16x32_bf16 v[156:159], v[20:23], v[48:51], v[156:159]
    ds_read_b64_tr_b16 v[42:43], v6 offset:17480
    s_waitcnt lgkmcnt(8)
    v_mfma_f32_16x16x32_bf16 v[160:163], v[16:19], v[52:55], v[160:163]
    ds_read_b64_tr_b16 v[44:45], v6 offset:17008
    v_mfma_f32_16x16x32_bf16 v[164:167], v[20:23], v[52:55], v[164:167]
    ds_read_b64_tr_b16 v[46:47], v6 offset:17520
    s_waitcnt lgkmcnt(8)
    v_mfma_f32_16x16x32_bf16 v[168:171], v[16:19], v[56:59], v[168:171]
    ds_read_b64_tr_b16 v[48:49], v6 offset:17040
    v_mfma_f32_16x16x32_bf16 v[172:175], v[20:23], v[56:59], v[172:175]
    ds_read_b64_tr_b16 v[50:51], v6 offset:17552
    s_waitcnt lgkmcnt(8)
    v_mfma_f32_16x16x32_bf16 v[64:67], v[24:27], v[32:35], v[64:67]
    ds_read_b64_tr_b16 v[52:53], v6 offset:17080
    v_mfma_f32_16x16x32_bf16 v[68:71], v[28:31], v[32:35], v[68:71]
    ds_read_b64_tr_b16 v[54:55], v6 offset:17592
    s_waitcnt lgkmcnt(8)
    v_mfma_f32_16x16x32_bf16 v[72:75], v[24:27], v[36:39], v[72:75]
    ds_read_b64_tr_b16 v[56:57], v6 offset:17112
    v_mfma_f32_16x16x32_bf16 v[76:79], v[28:31], v[36:39], v[76:79]
    ds_read_b64_tr_b16 v[58:59], v6 offset:17624
    s_waitcnt lgkmcnt(8)
    v_mfma_f32_16x16x32_bf16 v[80:83], v[24:27], v[40:43], v[80:83]
    ds_read_b64_tr_b16 v[32:33], v6 offset:17152
    v_mfma_f32_16x16x32_bf16 v[84:87], v[28:31], v[40:43], v[84:87]
    ds_read_b64_tr_b16 v[34:35], v6 offset:17664
    s_waitcnt lgkmcnt(8)
    v_mfma_f32_16x16x32_bf16 v[88:91], v[24:27], v[44:47], v[88:91]
    ds_read_b64_tr_b16 v[36:37], v7 offset:16896
    v_mfma_f32_16x16x32_bf16 v[92:95], v[28:31], v[44:47], v[92:95]
    ds_read_b64_tr_b16 v[38:39], v7 offset:17408
    s_waitcnt lgkmcnt(8)
    v_mfma_f32_16x16x32_bf16 v[96:99], v[24:27], v[48:51], v[96:99]
    ds_read_b64_tr_b16 v[40:41], v7 offset:16936
    v_mfma_f32_16x16x32_bf16 v[100:103], v[28:31], v[48:51], v[100:103]
    ds_read_b64_tr_b16 v[42:43], v7 offset:17448
    s_waitcnt lgkmcnt(8)
    v_mfma_f32_16x16x32_bf16 v[104:107], v[24:27], v[52:55], v[104:107]
    ds_read_b64_tr_b16 v[44:45], v7 offset:16968
    v_mfma_f32_16x16x32_bf16 v[108:111], v[28:31], v[52:55], v[108:111]
    ds_read_b64_tr_b16 v[46:47], v7 offset:17480
    s_waitcnt lgkmcnt(8)
    v_mfma_f32_16x16x32_bf16 v[112:115], v[24:27], v[56:59], v[112:115]
    ds_read_b64_tr_b16 v[48:49], v7 offset:17008
    v_mfma_f32_16x16x32_bf16 v[116:119], v[28:31], v[56:59], v[116:119]
    ds_read_b64_tr_b16 v[50:51], v7 offset:17520
    s_waitcnt lgkmcnt(8)
    v_mfma_f32_16x16x32_bf16 v[120:123], v[24:27], v[32:35], v[120:123]
    ds_read_b64_tr_b16 v[52:53], v10 offset:16896
    v_mfma_f32_16x16x32_bf16 v[124:127], v[28:31], v[32:35], v[124:127]
    ds_read_b64_tr_b16 v[54:55], v10 offset:17408
    s_waitcnt lgkmcnt(8)
    v_mfma_f32_16x16x32_bf16 v[128:131], v[24:27], v[36:39], v[128:131]
    ds_read_b64_tr_b16 v[56:57], v11 offset:16896
    v_mfma_f32_16x16x32_bf16 v[132:135], v[28:31], v[36:39], v[132:135]
    ds_read_b64_tr_b16 v[58:59], v11 offset:17408
    s_waitcnt lgkmcnt(8)
    v_mfma_f32_16x16x32_bf16 v[136:139], v[24:27], v[40:43], v[136:139]
    v_mfma_f32_16x16x32_bf16 v[140:143], v[28:31], v[40:43], v[140:143]
    s_waitcnt lgkmcnt(6)
    v_mfma_f32_16x16x32_bf16 v[144:147], v[24:27], v[44:47], v[144:147]
    v_mfma_f32_16x16x32_bf16 v[148:151], v[28:31], v[44:47], v[148:151]
    s_waitcnt lgkmcnt(0)
    s_barrier
    v_add_u32 v4, s50, v4
    v_add_u32 v10, s50, v10
    v_add_u32 v11, s50, v11
    v_add_u32 v6, s50, v6
    v_add_u32 v7, s50, v7
    ds_read_b64_tr_b16 v[32:33], v6 offset:0
    ds_read_b64_tr_b16 v[34:35], v6 offset:512
    ds_read_b64_tr_b16 v[36:37], v6 offset:40
    ds_read_b64_tr_b16 v[38:39], v6 offset:552
    v_mfma_f32_16x16x32_bf16 v[152:155], v[24:27], v[48:51], v[152:155]
    ds_read_b64_tr_b16 v[40:41], v6 offset:72
    ds_read_b64_tr_b16 v[42:43], v6 offset:584
    ds_read_b64_tr_b16 v[44:45], v6 offset:112
    v_mfma_f32_16x16x32_bf16 v[156:159], v[28:31], v[48:51], v[156:159]
    ds_read_b64_tr_b16 v[46:47], v6 offset:624
    ds_read_b128 v[16:19], v4 offset:0
    ds_read_b128 v[20:23], v4 offset:2048
    v_mfma_f32_16x16x32_bf16 v[160:163], v[24:27], v[52:55], v[160:163]
    ds_read_b64_tr_b16 v[48:49], v6 offset:144
    v_mfma_f32_16x16x32_bf16 v[164:167], v[28:31], v[52:55], v[164:167]
    v_add_u32 v5, s50, v5
    ds_read_b64_tr_b16 v[50:51], v6 offset:656
    v_mfma_f32_16x16x32_bf16 v[168:171], v[24:27], v[56:59], v[168:171]
    v_mfma_f32_16x16x32_bf16 v[172:175], v[28:31], v[56:59], v[172:175]
    s_add_u32 s48, s48, 1
    s_bitcmp1_b32 s55, s48
    s_cselect_b32 s50, s56, s57
    s_cmp_lt_u32 s48, 8
    s_cbranch_scc1 K1_LSS
    s_branch K1_EVV
K1_EQQ:
    s_waitcnt lgkmcnt(2)
    v_mfma_f32_16x16x32_bf16 v[64:67], v[32:35], v[16:19], v[64:67]
    ds_read_b64_tr_b16 v[52:53], v6 offset:16896
    ds_read_b64_tr_b16 v[54:55], v6 offset:17408
    v_mfma_f32_16x16x32_bf16 v[68:71], v[32:35], v[20:23], v[68:71]
    ds_read_b128 v[24:27], v5 offset:0
    ds_read_b128 v[28:31], v5 offset:2048
    s_waitcnt lgkmcnt(6)
    v_mfma_f32_16x16x32_bf16 v[72:75], v[36:39], v[16:19], v[72:75]
    ds_read_b64_tr_b16 v[56:57], v6 offset:16936
    v_mfma_f32_16x16x32_bf16 v[76:79], v[36:39], v[20:23], v[76:79]
    ds_read_b64_tr_b16 v[58:59], v6 offset:17448
    s_waitcnt lgkmcnt(8)
    v_mfma_f32_16x16x32_bf16 v[80:83], v[40:43], v[16:19], v[80:83]
    ds_read_b64_tr_b16 v[32:33], v6 offset:16968
    v_mfma_f32_16x16x32_bf16 v[84:87], v[40:43], v[20:23], v[84:87]
    ds_read_b64_tr_b16 v[34:35], v6 offset:17480
    s_waitcnt lgkmcnt(10)
    v_mfma_f32_16x16x32_bf16 v[88:91], v[44:47], v[16:19], v[88:91]
    ds_read_b64_tr_b16 v[36:37], v6 offset:17008
    v_mfma_f32_16x16x32_bf16 v[92:95], v[44:47], v[20:23], v[92:95]
    ds_read_b64_tr_b16 v[38:39], v6 offset:17520
    s_waitcnt lgkmcnt(10)
    v_mfma_f32_16x16x32_bf16 v[96:99], v[48:51], v[16:19], v[96:99]
    ds_read_b64_tr_b16 v[40:41], v6 offset:17040
    v_mfma_f32_16x16x32_bf16 v[100:103], v[48:51], v[20:23], v[100:103]
    ds_read_b64_tr_b16 v[42:43], v6 offset:17552
    s_waitcnt lgkmcnt(8)
    v_mfma_f32_16x16x32_bf16 v[64:67], v[52:55], v[24:27], v[64:67]
    ds_read_b64_tr_b16 v[44:45], v6 offset:184
    v_mfma_f32_16x16x32_bf16 v[68:71], v[52:55], v[28:31], v[68:71]
    ds_read_b64_tr_b16 v[46:47], v6 offset:696
    s_waitcnt lgkmcnt(8)
    v_mfma_f32_16x16x32_bf16 v[72:75], v[56:59], v[24:27], v[72:75]
    ds_read_b64_tr_b16 v[48:49], v6 offset:216
    v_mfma_f32_16x16x32_bf16 v[76:79], v[56:59], v[28:31], v[76:79]
    ds_read_b64_tr_b16 v[50:51], v6 offset:728
    s_waitcnt lgkmcnt(8)
    v_mfma_f32_16x16x32_bf16 v[80:83], v[32:35], v[24:27], v[80:83]
    ds_read_b64_tr_b16 v[52:53], v6 offset:17080
    v_mfma_f32_16x16x32_bf16 v[84:87], v[32:35], v[28:31], v[84:87]
    ds_read_b64_tr_b16 v[54:55], v6 offset:17592
    v_pk_mul_f32 v[64:65], v[64:65], s[22:23]
    v_pk_mul_f32 v[66:67], v[66:67], s[22:23]
    v_pk_mul_f32 v[68:69], v[68:69], s[22:23]
    v_pk_mul_f32 v[70:71], v[70:71], s[22:23]
    v_cvt_pk_bf16_f32 v64, v64, v65
    v_cvt_pk_bf16_f32 v65, v66, v67
    v_cvt_pk_bf16_f32 v66, v68, v69
    v_cvt_pk_bf16_f32 v67, v70, v71
    s_add_u32 s3, s26, 0
    s_add_u32 s3, s3, s21
    v_permlane16_swap_b32 v64, v66
    v_permlane16_swap_b32 v65, v67
    buffer_store_dwordx4 v[64:67], v12, s[12:15], s3 offen sc1
    s_waitcnt lgkmcnt(8)
    v_mfma_f32_16x16x32_bf16 v[88:91], v[36:39], v[24:27], v[88:91]
    ds_read_b64_tr_b16 v[56:57], v6 offset:17112
    v_mfma_f32_16x16x32_bf16 v[92:95], v[36:39], v[28:31], v[92:95]
    ds_read_b64_tr_b16 v[58:59], v6 offset:17624
    v_pk_mul_f32 v[72:73], v[72:73], s[22:23]
    v_pk_mul_f32 v[74:75], v[74:75], s[22:23]
    v_pk_mul_f32 v[76:77], v[76:77], s[22:23]
    v_pk_mul_f32 v[78:79], v[78:79], s[22:23]
    v_cvt_pk_bf16_f32 v72, v72, v73
    v_cvt_pk_bf16_f32 v73, v74, v75
    v_cvt_pk_bf16_f32 v74, v76, v77
    v_cvt_pk_bf16_f32 v75, v78, v79
    s_add_u32 s3, s26, 229376
    s_add_u32 s3, s3, s21
    v_permlane16_swap_b32 v72, v74
    v_permlane16_swap_b32 v73, v75
    buffer_store_dwordx4 v[72:75], v12, s[12:15], s3 offen sc1
    s_waitcnt lgkmcnt(8)
    v_mfma_f32_16x16x32_bf16 v[96:99], v[40:43], v[24:27], v[96:99]
    ds_read_b64_tr_b16 v[32:33], v6 offset:256
    v_mfma_f32_16x16x32_bf16 v[100:103], v[40:43], v[28:31], v[100:103]
    ds_read_b64_tr_b16 v[34:35], v6 offset:768
    v_pk_mul_f32 v[80:81], v[80:81], s[22:23]
    v_pk_mul_f32 v[82:83], v[82:83], s[22:23]
    v_pk_mul_f32 v[84:85], v[84:85], s[22:23]
    v_pk_mul_f32 v[86:87], v[86:87], s[22:23]
    v_cvt_pk_bf16_f32 v80, v80, v81
    v_cvt_pk_bf16_f32 v81, v82, v83
    v_cvt_pk_bf16_f32 v82, v84, v85
    v_cvt_pk_bf16_f32 v83, v86, v87
    s_add_u32 s3, s26, 458752
    s_add_u32 s3, s3, s21
    v_permlane16_swap_b32 v80, v82
    v_permlane16_swap_b32 v81, v83
    buffer_store_dwordx4 v[80:83], v12, s[12:15], s3 offen sc1
    s_waitcnt lgkmcnt(8)
    v_mfma_f32_16x16x32_bf16 v[104:107], v[44:47], v[16:19], v[104:107]
    ds_read_b64_tr_b16 v[36:37], v7 offset:0
    v_mfma_f32_16x16x32_bf16 v[108:111], v[44:47], v[20:23], v[108:111]
    ds_read_b64_tr_b16 v[38:39], v7 offset:512
    v_pk_mul_f32 v[88:89], v[88:89], s[22:23]
    v_pk_mul_f32 v[90:91], v[90:91], s[22:23]
    v_pk_mul_f32 v[92:93], v[92:93], s[22:23]
    v_pk_mul_f32 v[94:95], v[94:95], s[22:23]
    v_cvt_pk_bf16_f32 v88, v88, v89
    v_cvt_pk_bf16_f32 v89, v90, v91
    v_cvt_pk_bf16_f32 v90, v92, v93
    v_cvt_pk_bf16_f32 v91, v94, v95
    s_add_u32 s3, s26, 688128
    s_add_u32 s3, s3, s21
    v_permlane16_swap_b32 v88, v90
    v_permlane16_swap_b32 v89, v91
    buffer_store_dwordx4 v[88:91], v12, s[12:15], s3 offen sc1
    s_waitcnt lgkmcnt(8)
    v_mfma_f32_16x16x32_bf16 v[112:115], v[48:51], v[16:19], v[112:115]
    ds_read_b64_tr_b16 v[40:41], v6 offset:17152
    v_mfma_f32_16x16x32_bf16 v[116:119], v[48:51], v[20:23], v[116:119]
    ds_read_b64_tr_b16 v[42:43], v6 offset:17664
    v_pk_mul_f32 v[96:97], v[96:97], s[22:23]
    v_pk_mul_f32 v[98:99], v[98:99], s[22:23]
    v_pk_mul_f32 v[100:101], v[100:101], s[22:23]
    v_pk_mul_f32 v[102:103], v[102:103], s[22:23]
    v_cvt_pk_bf16_f32 v96, v96, v97
    v_cvt_pk_bf16_f32 v97, v98, v99
    v_cvt_pk_bf16_f32 v98, v100, v101
    v_cvt_pk_bf16_f32 v99, v102, v103
    s_add_u32 s3, s26, 917504
    s_add_u32 s3, s3, s21
    v_permlane16_swap_b32 v96, v98
    v_permlane16_swap_b32 v97, v99
    buffer_store_dwordx4 v[96:99], v12, s[12:15], s3 offen sc1
    s_waitcnt lgkmcnt(8)
    v_mfma_f32_16x16x32_bf16 v[104:107], v[52:55], v[24:27], v[104:107]
    ds_read_b64_tr_b16 v[44:45], v7 offset:16896
    v_mfma_f32_16x16x32_bf16 v[108:111], v[52:55], v[28:31], v[108:111]
    ds_read_b64_tr_b16 v[46:47], v7 offset:17408
    s_waitcnt lgkmcnt(8)
    v_mfma_f32_16x16x32_bf16 v[112:115], v[56:59], v[24:27], v[112:115]
    ds_read_b64_tr_b16 v[48:49], v7 offset:40
    v_mfma_f32_16x16x32_bf16 v[116:119], v[56:59], v[28:31], v[116:119]
    ds_read_b64_tr_b16 v[50:51], v7 offset:552
    s_waitcnt lgkmcnt(8)
    v_mfma_f32_16x16x32_bf16 v[120:123], v[32:35], v[16:19], v[120:123]
    ds_read_b64_tr_b16 v[52:53], v7 offset:72
    v_mfma_f32_16x16x32_bf16 v[124:127], v[32:35], v[20:23], v[124:127]
    ds_read_b64_tr_b16 v[54:55], v7 offset:584
    v_pk_mul_f32 v[104:105], v[104:105], s[22:23]
    v_pk_mul_f32 v[106:107], v[106:107], s[22:23]
    v_pk_mul_f32 v[108:109], v[108:109], s[22:23]
    v_pk_mul_f32 v[110:111], v[110:111], s[22:23]
    v_cvt_pk_bf16_f32 v104, v104, v105
    v_cvt_pk_bf16_f32 v105, v106, v107
    v_cvt_pk_bf16_f32 v106, v108, v109
    v_cvt_pk_bf16_f32 v107, v110, v111
    s_add_u32 s3, s26, 1146880
    s_add_u32 s3, s3, s21
    v_permlane16_swap_b32 v104, v106
    v_permlane16_swap_b32 v105, v107
    buffer_store_dwordx4 v[104:107], v12, s[12:15], s3 offen sc1
    s_waitcnt lgkmcnt(8)
    v_mfma_f32_16x16x32_bf16 v[128:131], v[36:39], v[16:19], v[128:131]
    ds_read_b64_tr_b16 v[56:57], v7 offset:16936
    v_mfma_f32_16x16x32_bf16 v[132:135], v[36:39], v[20:23], v[132:135]
    ds_read_b64_tr_b16 v[58:59], v7 offset:17448
    v_pk_mul_f32 v[112:113], v[112:113], s[22:23]
    v_pk_mul_f32 v[114:115], v[114:115], s[22:23]
    v_pk_mul_f32 v[116:117], v[116:117], s[22:23]
    v_pk_mul_f32 v[118:119], v[118:119], s[22:23]
    v_cvt_pk_bf16_f32 v112, v112, v113
    v_cvt_pk_bf16_f32 v113, v114, v115
    v_cvt_pk_bf16_f32 v114, v116, v117
    v_cvt_pk_bf16_f32 v115, v118, v119
    s_add_u32 s3, s26, 1376256
    s_add_u32 s3, s3, s21
    v_permlane16_swap_b32 v112, v114
    v_permlane16_swap_b32 v113, v115
    buffer_store_dwordx4 v[112:115], v12, s[12:15], s3 offen sc1
    s_waitcnt lgkmcnt(8)
    v_mfma_f32_16x16x32_bf16 v[120:123], v[40:43], v[24:27], v[120:123]
    ds_read_b64_tr_b16 v[32:33], v7 offset:16968
    v_mfma_f32_16x16x32_bf16 v[124:127], v[40:43], v[28:31], v[124:127]
    ds_read_b64_tr_b16 v[34:35], v7 offset:17480
    s_waitcnt lgkmcnt(8)
    v_mfma_f32_16x16x32_bf16 v[128:131], v[44:47], v[24:27], v[128:131]
    ds_read_b64_tr_b16 v[36:37], v7 offset:112
    v_mfma_f32_16x16x32_bf16 v[132:135], v[44:47], v[28:31], v[132:135]
    ds_read_b64_tr_b16 v[38:39], v7 offset:624
    s_waitcnt lgkmcnt(8)
    v_mfma_f32_16x16x32_bf16 v[136:139], v[48:51], v[16:19], v[136:139]
    ds_read_b64_tr_b16 v[40:41], v10 offset:0
    v_mfma_f32_16x16x32_bf16 v[140:143], v[48:51], v[20:23], v[140:143]
    ds_read_b64_tr_b16 v[42:43], v10 offset:512
    v_pk_mul_f32 v[120:121], v[120:121], s[22:23]
    v_pk_mul_f32 v[122:123], v[122:123], s[22:23]
    v_pk_mul_f32 v[124:125], v[124:125], s[22:23]
    v_pk_mul_f32 v[126:127], v[126:127], s[22:23]
    v_cvt_pk_bf16_f32 v120, v120, v121
    v_cvt_pk_bf16_f32 v121, v122, v123
    v_cvt_pk_bf16_f32 v122, v124, v125
    v_cvt_pk_bf16_f32 v123, v126, v127
    s_add_u32 s3, s26, 1605632
    s_add_u32 s3, s3, s21
    v_permlane16_swap_b32 v120, v122
    v_permlane16_swap_b32 v121, v123
    buffer_store_dwordx4 v[120:123], v12, s[12:15], s3 offen sc1
    s_waitcnt lgkmcnt(8)
    v_mfma_f32_16x16x32_bf16 v[144:147], v[52:55], v[16:19], v[144:147]
    ds_read_b64_tr_b16 v[44:45], v11 offset:0
    v_mfma_f32_16x16x32_bf16 v[148:151], v[52:55], v[20:23], v[148:151]
    ds_read_b64_tr_b16 v[46:47], v11 offset:512
    v_pk_mul_f32 v[128:129], v[128:129], s[22:23]
    v_pk_mul_f32 v[130:131], v[130:131], s[22:23]
    v_pk_mul_f32 v[132:133], v[132:133], s[22:23]
    v_pk_mul_f32 v[134:135], v[134:135], s[22:23]
    v_cvt_pk_bf16_f32 v128, v128, v129
    v_cvt_pk_bf16_f32 v129, v130, v131
    v_cvt_pk_bf16_f32 v130, v132, v133
    v_cvt_pk_bf16_f32 v131, v134, v135
    s_add_u32 s3, s27, 0
    s_add_u32 s3, s3, s21
    v_permlane16_swap_b32 v128, v130
    v_permlane16_swap_b32 v129, v131
    buffer_store_dwordx4 v[128:131], v12, s[12:15], s3 offen sc1
    s_waitcnt lgkmcnt(8)
    v_mfma_f32_16x16x32_bf16 v[136:139], v[56:59], v[24:27], v[136:139]
    ds_read_b64_tr_b16 v[48:49], v7 offset:17008
    v_mfma_f32_16x16x32_bf16 v[140:143], v[56:59], v[28:31], v[140:143]
    ds_read_b64_tr_b16 v[50:51], v7 offset:17520
    s_waitcnt lgkmcnt(8)
    v_mfma_f32_16x16x32_bf16 v[144:147], v[32:35], v[24:27], v[144:147]
    ds_read_b64_tr_b16 v[52:53], v10 offset:16896
    v_mfma_f32_16x16x32_bf16 v[148:151], v[32:35], v[28:31], v[148:151]
    ds_read_b64_tr_b16 v[54:55], v10 offset:17408
    s_waitcnt lgkmcnt(8)
    v_mfma_f32_16x16x32_bf16 v[152:155], v[36:39], v[16:19], v[152:155]
    ds_read_b64_tr_b16 v[56:57], v11 offset:16896
    v_mfma_f32_16x16x32_bf16 v[156:159], v[36:39], v[20:23], v[156:159]
    ds_read_b64_tr_b16 v[58:59], v11 offset:17408
    v_pk_mul_f32 v[136:137], v[136:137], s[22:23]
    v_pk_mul_f32 v[138:139], v[138:139], s[22:23]
    v_pk_mul_f32 v[140:141], v[140:141], s[22:23]
    v_pk_mul_f32 v[142:143], v[142:143], s[22:23]
    v_cvt_pk_bf16_f32 v136, v136, v137
    v_cvt_pk_bf16_f32 v137, v138, v139
    v_cvt_pk_bf16_f32 v138, v140, v141
    v_cvt_pk_bf16_f32 v139, v142, v143
    s_add_u32 s3, s27, 229376
    s_add_u32 s3, s3, s21
    v_permlane16_swap_b32 v136, v138
    v_permlane16_swap_b32 v137, v139
    buffer_store_dwordx4 v[136:139], v12, s[12:15], s3 offen sc1
    s_waitcnt lgkmcnt(8)
    v_mfma_f32_16x16x32_bf16 v[160:163], v[40:43], v[16:19], v[160:163]
    v_mfma_f32_16x16x32_bf16 v[164:167], v[40:43], v[20:23], v[164:167]
    v_pk_mul_f32 v[144:145], v[144:145], s[22:23]
    v_pk_mul_f32 v[146:147], v[146:147], s[22:23]
    v_pk_mul_f32 v[148:149], v[148:149], s[22:23]
    v_pk_mul_f32 v[150:151], v[150:151], s[22:23]
    v_cvt_pk_bf16_f32 v144, v144, v145
    v_cvt_pk_bf16_f32 v145, v146, v147
    v_cvt_pk_bf16_f32 v146, v148, v149
    v_cvt_pk_bf16_f32 v147, v150, v151
    s_add_u32 s3, s27, 458752
    s_add_u32 s3, s3, s21
    v_permlane16_swap_b32 v144, v146
    v_permlane16_swap_b32 v145, v147
    buffer_store_dwordx4 v[144:147], v12, s[12:15], s3 offen sc1
    s_waitcnt lgkmcnt(6)
    v_mfma_f32_16x16x32_bf16 v[168:171], v[44:47], v[16:19], v[168:171]
    v_mfma_f32_16x16x32_bf16 v[172:175], v[44:47], v[20:23], v[172:175]
    s_waitcnt lgkmcnt(4)
    v_mfma_f32_16x16x32_bf16 v[152:155], v[48:51], v[24:27], v[152:155]
    v_mfma_f32_16x16x32_bf16 v[156:159], v[48:51], v[28:31], v[156:159]
    s_waitcnt lgkmcnt(2)
    v_mfma_f32_16x16x32_bf16 v[160:163], v[52:55], v[24:27], v[160:163]
    v_mfma_f32_16x16x32_bf16 v[164:167], v[52:55], v[28:31], v[164:167]
    s_waitcnt lgkmcnt(0)
    v_mfma_f32_16x16x32_bf16 v[168:171], v[56:59], v[24:27], v[168:171]
    v_mfma_f32_16x16x32_bf16 v[172:175], v[56:59], v[28:31], v[172:175]
    v_pk_mul_f32 v[152:153], v[152:153], s[22:23]
    v_pk_mul_f32 v[154:155], v[154:155], s[22:23]
    v_pk_mul_f32 v[156:157], v[156:157], s[22:23]
    v_pk_mul_f32 v[158:159], v[158:159], s[22:23]
    v_cvt_pk_bf16_f32 v152, v152, v153
    v_cvt_pk_bf16_f32 v153, v154, v155
    v_cvt_pk_bf16_f32 v154, v156, v157
    v_cvt_pk_bf16_f32 v155, v158, v159
    s_add_u32 s3, s27, 688128
    s_add_u32 s3, s3, s21
    v_permlane16_swap_b32 v152, v154
    v_permlane16_swap_b32 v153, v155
    buffer_store_dwordx4 v[152:155], v12, s[12:15], s3 offen sc1
    s_nop 7
    s_lshl_b32 s3, s24, 2
    s_add_u32 s3, s3, s26
    s_add_u32 s3, s3, 65536
    v_lshlrev_b32 v14, 2, v3
    v_add_u32 v14, v14, v13
    v_add_u32 v15, 229376, v14
    v_pk_mul_f32 v[160:161], v[160:161], s[22:23]
    v_pk_mul_f32 v[162:163], v[162:163], s[22:23]
    v_cvt_pk_bf16_f32 v160, v160, v161
    v_cvt_pk_bf16_f32 v161, v162, v163
    buffer_store_dword v160, v14, s[12:15], s3 offen offset:0
    buffer_store_dword v161, v15, s[12:15], s3 offen offset:0
    v_pk_mul_f32 v[164:165], v[164:165], s[22:23]
    v_pk_mul_f32 v[166:167], v[166:167], s[22:23]
    v_cvt_pk_bf16_f32 v164, v164, v165
    v_cvt_pk_bf16_f32 v165, v166, v167
    buffer_store_dword v164, v14, s[12:15], s3 offen offset:64
    buffer_store_dword v165, v15, s[12:15], s3 offen offset:64
    s_lshl_b32 s3, s24, 2
    s_add_u32 s3, s3, s27
    s_add_u32 s3, s3, 65536
    v_lshlrev_b32 v14, 2, v3
    v_add_u32 v14, v14, v13
    v_add_u32 v15, 229376, v14
    s_mov_b32 exec_hi, 0
    v_pk_mul_f32 v[168:169], v[168:169], s[22:23]
    v_pk_mul_f32 v[170:171], v[170:171], s[22:23]
    v_cvt_pk_bf16_f32 v168, v168, v169
    v_cvt_pk_bf16_f32 v169, v170, v171
    buffer_store_dword v168, v14, s[12:15], s3 offen offset:0
    buffer_store_dword v169, v15, s[12:15], s3 offen offset:0
    v_pk_mul_f32 v[172:173], v[172:173], s[22:23]
    v_pk_mul_f32 v[174:175], v[174:175], s[22:23]
    v_cvt_pk_bf16_f32 v172, v172, v173
    v_cvt_pk_bf16_f32 v173, v174, v175
    buffer_store_dword v172, v14, s[12:15], s3 offen offset:64
    buffer_store_dword v173, v15, s[12:15], s3 offen offset:64
    s_mov_b64 exec, -1
    s_branch K1_FIN
K1_EQK:
    s_waitcnt lgkmcnt(2)
    v_mfma_f32_16x16x32_bf16 v[64:67], v[32:35], v[16:19], v[64:67]
    ds_read_b64_tr_b16 v[52:53], v6 offset:16896
    ds_read_b64_tr_b16 v[54:55], v6 offset:17408
    v_mfma_f32_16x16x32_bf16 v[68:71], v[32:35], v[20:23], v[68:71]
    ds_read_b128 v[24:27], v5 offset:0
    ds_read_b128 v[28:31], v5 offset:2048
    s_waitcnt lgkmcnt(6)
    v_mfma_f32_16x16x32_bf16 v[72:75], v[36:39], v[16:19], v[72:75]
    ds_read_b64_tr_b16 v[56:57], v6 offset:16936
    v_mfma_f32_16x16x32_bf16 v[76:79], v[36:39], v[20:23], v[76:79]
    ds_read_b64_tr_b16 v[58:59], v6 offset:17448
    s_waitcnt lgkmcnt(8)
    v_mfma_f32_16x16x32_bf16 v[80:83], v[40:43], v[16:19], v[80:83]
    ds_read_b64_tr_b16 v[32:33], v6 offset:16968
    v_mfma_f32_16x16x32_bf16 v[84:87], v[40:43], v[20:23], v[84:87]
    ds_read_b64_tr_b16 v[34:35], v6 offset:17480
    s_waitcnt lgkmcnt(10)
    v_mfma_f32_16x16x32_bf16 v[88:91], v[44:47], v[16:19], v[88:91]
    ds_read_b64_tr_b16 v[36:37], v6 offset:17008
    v_mfma_f32_16x16x32_bf16 v[92:95], v[44:47], v[20:23], v[92:95]
    ds_read_b64_tr_b16 v[38:39], v6 offset:17520
    s_waitcnt lgkmcnt(10)
    v_mfma_f32_16x16x32_bf16 v[96:99], v[48:51], v[16:19], v[96:99]
    ds_read_b64_tr_b16 v[40:41], v6 offset:17040
    v_mfma_f32_16x16x32_bf16 v[100:103], v[48:51], v[20:23], v[100:103]
    ds_read_b64_tr_b16 v[42:43], v6 offset:17552
    s_waitcnt lgkmcnt(8)
    v_mfma_f32_16x16x32_bf16 v[64:67], v[52:55], v[24:27], v[64:67]
    ds_read_b64_tr_b16 v[44:45], v6 offset:184
    v_mfma_f32_16x16x32_bf16 v[68:71], v[52:55], v[28:31], v[68:71]
    ds_read_b64_tr_b16 v[46:47], v6 offset:696
    s_waitcnt lgkmcnt(8)
    v_mfma_f32_16x16x32_bf16 v[72:75], v[56:59], v[24:27], v[72:75]
    ds_read_b64_tr_b16 v[48:49], v6 offset:216
    v_mfma_f32_16x16x32_bf16 v[76:79], v[56:59], v[28:31], v[76:79]
    ds_read_b64_tr_b16 v[50:51], v6 offset:728
    s_waitcnt lgkmcnt(8)
    v_mfma_f32_16x16x32_bf16 v[80:83], v[32:35], v[24:27], v[80:83]
    ds_read_b64_tr_b16 v[52:53], v6 offset:17080
    v_mfma_f32_16x16x32_bf16 v[84:87], v[32:35], v[28:31], v[84:87]
    ds_read_b64_tr_b16 v[54:55], v6 offset:17592
    v_pk_mul_f32 v[64:65], v[64:65], s[22:23]
    v_pk_mul_f32 v[66:67], v[66:67], s[22:23]
    v_pk_mul_f32 v[68:69], v[68:69], s[22:23]
    v_pk_mul_f32 v[70:71], v[70:71], s[22:23]
    v_cvt_pk_bf16_f32 v64, v64, v65
    v_cvt_pk_bf16_f32 v65, v66, v67
    v_cvt_pk_bf16_f32 v66, v68, v69
    v_cvt_pk_bf16_f32 v67, v70, v71
    s_add_u32 s3, s26, 0
    s_add_u32 s3, s3, s21
    v_permlane16_swap_b32 v64, v66
    v_permlane16_swap_b32 v65, v67
    buffer_store_dwordx4 v[64:67], v12, s[12:15], s3 offen sc1
    s_waitcnt lgkmcnt(8)
    v_mfma_f32_16x16x32_bf16 v[88:91], v[36:39], v[24:27], v[88:91]
    ds_read_b64_tr_b16 v[56:57], v6 offset:17112
    v_mfma_f32_16x16x32_bf16 v[92:95], v[36:39], v[28:31], v[92:95]
    ds_read_b64_tr_b16 v[58:59], v6 offset:17624
    v_pk_mul_f32 v[72:73], v[72:73], s[22:23]
    v_pk_mul_f32 v[74:75], v[74:75], s[22:23]
    v_pk_mul_f32 v[76:77], v[76:77], s[22:23]
    v_pk_mul_f32 v[78:79], v[78:79], s[22:23]
    v_cvt_pk_bf16_f32 v72, v72, v73
    v_cvt_pk_bf16_f32 v73, v74, v75
    v_cvt_pk_bf16_f32 v74, v76, v77
    v_cvt_pk_bf16_f32 v75, v78, v79
    s_add_u32 s3, s26, 229376
    s_add_u32 s3, s3, s21
    v_permlane16_swap_b32 v72, v74
    v_permlane16_swap_b32 v73, v75
    buffer_store_dwordx4 v[72:75], v12, s[12:15], s3 offen sc1
    s_waitcnt lgkmcnt(8)
    v_mfma_f32_16x16x32_bf16 v[96:99], v[40:43], v[24:27], v[96:99]
    ds_read_b64_tr_b16 v[32:33], v6 offset:256
    v_mfma_f32_16x16x32_bf16 v[100:103], v[40:43], v[28:31], v[100:103]
    ds_read_b64_tr_b16 v[34:35], v6 offset:768
    v_pk_mul_f32 v[80:81], v[80:81], s[22:23]
    v_pk_mul_f32 v[82:83], v[82:83], s[22:23]
    v_pk_mul_f32 v[84:85], v[84:85], s[22:23]
    v_pk_mul_f32 v[86:87], v[86:87], s[22:23]
    v_cvt_pk_bf16_f32 v80, v80, v81
    v_cvt_pk_bf16_f32 v81, v82, v83
    v_cvt_pk_bf16_f32 v82, v84, v85
    v_cvt_pk_bf16_f32 v83, v86, v87
    s_add_u32 s3, s26, 458752
    s_add_u32 s3, s3, s21
    v_permlane16_swap_b32 v80, v82
    v_permlane16_swap_b32 v81, v83
    buffer_store_dwordx4 v[80:83], v12, s[12:15], s3 offen sc1
    s_waitcnt lgkmcnt(8)
    v_mfma_f32_16x16x32_bf16 v[104:107], v[44:47], v[16:19], v[104:107]
    ds_read_b64_tr_b16 v[36:37], v7 offset:0
    v_mfma_f32_16x16x32_bf16 v[108:111], v[44:47], v[20:23], v[108:111]
    ds_read_b64_tr_b16 v[38:39], v7 offset:512
    v_pk_mul_f32 v[88:89], v[88:89], s[22:23]
    v_pk_mul_f32 v[90:91], v[90:91], s[22:23]
    v_pk_mul_f32 v[92:93], v[92:93], s[22:23]
    v_pk_mul_f32 v[94:95], v[94:95], s[22:23]
    v_cvt_pk_bf16_f32 v88, v88, v89
    v_cvt_pk_bf16_f32 v89, v90, v91
    v_cvt_pk_bf16_f32 v90, v92, v93
    v_cvt_pk_bf16_f32 v91, v94, v95
    s_add_u32 s3, s26, 688128
    s_add_u32 s3, s3, s21
    v_permlane16_swap_b32 v88, v90
    v_permlane16_swap_b32 v89, v91
    buffer_store_dwordx4 v[88:91], v12, s[12:15], s3 offen sc1
    s_waitcnt lgkmcnt(8)
    v_mfma_f32_16x16x32_bf16 v[112:115], v[48:51], v[16:19], v[112:115]
    ds_read_b64_tr_b16 v[40:41], v6 offset:17152
    v_mfma_f32_16x16x32_bf16 v[116:119], v[48:51], v[20:23], v[116:119]
    ds_read_b64_tr_b16 v[42:43], v6 offset:17664
    v_pk_mul_f32 v[96:97], v[96:97], s[22:23]
    v_pk_mul_f32 v[98:99], v[98:99], s[22:23]
    v_pk_mul_f32 v[100:101], v[100:101], s[22:23]
    v_pk_mul_f32 v[102:103], v[102:103], s[22:23]
    v_cvt_pk_bf16_f32 v96, v96, v97
    v_cvt_pk_bf16_f32 v97, v98, v99
    v_cvt_pk_bf16_f32 v98, v100, v101
    v_cvt_pk_bf16_f32 v99, v102, v103
    s_add_u32 s3, s26, 917504
    s_add_u32 s3, s3, s21
    v_permlane16_swap_b32 v96, v98
    v_permlane16_swap_b32 v97, v99
    buffer_store_dwordx4 v[96:99], v12, s[12:15], s3 offen sc1
    s_waitcnt lgkmcnt(8)
    v_mfma_f32_16x16x32_bf16 v[104:107], v[52:55], v[24:27], v[104:107]
    ds_read_b64_tr_b16 v[44:45], v7 offset:16896
    v_mfma_f32_16x16x32_bf16 v[108:111], v[52:55], v[28:31], v[108:111]
    ds_read_b64_tr_b16 v[46:47], v7 offset:17408
    s_waitcnt lgkmcnt(8)
    v_mfma_f32_16x16x32_bf16 v[112:115], v[56:59], v[24:27], v[112:115]
    ds_read_b64_tr_b16 v[48:49], v7 offset:40
    v_mfma_f32_16x16x32_bf16 v[116:119], v[56:59], v[28:31], v[116:119]
    ds_read_b64_tr_b16 v[50:51], v7 offset:552
    s_waitcnt lgkmcnt(8)
    v_mfma_f32_16x16x32_bf16 v[120:123], v[32:35], v[16:19], v[120:123]
    ds_read_b64_tr_b16 v[52:53], v7 offset:72
    v_mfma_f32_16x16x32_bf16 v[124:127], v[32:35], v[20:23], v[124:127]
    ds_read_b64_tr_b16 v[54:55], v7 offset:584
    v_pk_mul_f32 v[104:105], v[104:105], s[22:23]
    v_pk_mul_f32 v[106:107], v[106:107], s[22:23]
    v_pk_mul_f32 v[108:109], v[108:109], s[22:23]
    v_pk_mul_f32 v[110:111], v[110:111], s[22:23]
    v_cvt_pk_bf16_f32 v104, v104, v105
    v_cvt_pk_bf16_f32 v105, v106, v107
    v_cvt_pk_bf16_f32 v106, v108, v109
    v_cvt_pk_bf16_f32 v107, v110, v111
    s_add_u32 s3, s26, 1146880
    s_add_u32 s3, s3, s21
    v_permlane16_swap_b32 v104, v106
    v_permlane16_swap_b32 v105, v107
    buffer_store_dwordx4 v[104:107], v12, s[12:15], s3 offen sc1
    s_waitcnt lgkmcnt(8)
    v_mfma_f32_16x16x32_bf16 v[128:131], v[36:39], v[16:19], v[128:131]
    ds_read_b64_tr_b16 v[56:57], v7 offset:16936
    v_mfma_f32_16x16x32_bf16 v[132:135], v[36:39], v[20:23], v[132:135]
    ds_read_b64_tr_b16 v[58:59], v7 offset:17448
    v_pk_mul_f32 v[112:113], v[112:113], s[22:23]
    v_pk_mul_f32 v[114:115], v[114:115], s[22:23]
    v_pk_mul_f32 v[116:117], v[116:117], s[22:23]
    v_pk_mul_f32 v[118:119], v[118:119], s[22:23]
    v_cvt_pk_bf16_f32 v112, v112, v113
    v_cvt_pk_bf16_f32 v113, v114, v115
    v_cvt_pk_bf16_f32 v114, v116, v117
    v_cvt_pk_bf16_f32 v115, v118, v119
    s_add_u32 s3, s26, 1376256
    s_add_u32 s3, s3, s21
    v_permlane16_swap_b32 v112, v114
    v_permlane16_swap_b32 v113, v115
    buffer_store_dwordx4 v[112:115], v12, s[12:15], s3 offen sc1
    s_waitcnt lgkmcnt(8)
    v_mfma_f32_16x16x32_bf16 v[120:123], v[40:43], v[24:27], v[120:123]
    ds_read_b64_tr_b16 v[32:33], v7 offset:16968
    v_mfma_f32_16x16x32_bf16 v[124:127], v[40:43], v[28:31], v[124:127]
    ds_read_b64_tr_b16 v[34:35], v7 offset:17480
    s_waitcnt lgkmcnt(8)
    v_mfma_f32_16x16x32_bf16 v[128:131], v[44:47], v[24:27], v[128:131]
    ds_read_b64_tr_b16 v[36:37], v7 offset:112
    v_mfma_f32_16x16x32_bf16 v[132:135], v[44:47], v[28:31], v[132:135]
    ds_read_b64_tr_b16 v[38:39], v7 offset:624
    s_waitcnt lgkmcnt(8)
    v_mfma_f32_16x16x32_bf16 v[136:139], v[48:51], v[16:19], v[136:139]
    ds_read_b64_tr_b16 v[40:41], v10 offset:0
    v_mfma_f32_16x16x32_bf16 v[140:143], v[48:51], v[20:23], v[140:143]
    ds_read_b64_tr_b16 v[42:43], v10 offset:512
    v_pk_mul_f32 v[120:121], v[120:121], s[22:23]
    v_pk_mul_f32 v[122:123], v[122:123], s[22:23]
    v_pk_mul_f32 v[124:125], v[124:125], s[22:23]
    v_pk_mul_f32 v[126:127], v[126:127], s[22:23]
    v_cvt_pk_bf16_f32 v120, v120, v121
    v_cvt_pk_bf16_f32 v121, v122, v123
    v_cvt_pk_bf16_f32 v122, v124, v125
    v_cvt_pk_bf16_f32 v123, v126, v127
    s_add_u32 s3, s26, 1605632
    s_add_u32 s3, s3, s21
    v_permlane16_swap_b32 v120, v122
    v_permlane16_swap_b32 v121, v123
    buffer_store_dwordx4 v[120:123], v12, s[12:15], s3 offen sc1
    s_waitcnt lgkmcnt(8)
    v_mfma_f32_16x16x32_bf16 v[144:147], v[52:55], v[16:19], v[144:147]
    ds_read_b64_tr_b16 v[44:45], v11 offset:0
    v_mfma_f32_16x16x32_bf16 v[148:151], v[52:55], v[20:23], v[148:151]
    ds_read_b64_tr_b16 v[46:47], v11 offset:512
    v_cvt_pk_bf16_f32 v128, v128, v129
    v_cvt_pk_bf16_f32 v129, v130, v131
    v_cvt_pk_bf16_f32 v130, v132, v133
    v_cvt_pk_bf16_f32 v131, v134, v135
    s_add_u32 s3, s27, 73728
    s_add_u32 s3, s3, s21
    v_permlane16_swap_b32 v128, v130
    v_permlane16_swap_b32 v129, v131
    buffer_store_dwordx4 v[128:131], v12, s[12:15], s3 offen sc1
    s_waitcnt lgkmcnt(8)
    v_mfma_f32_16x16x32_bf16 v[136:139], v[56:59], v[24:27], v[136:139]
    ds_read_b64_tr_b16 v[48:49], v7 offset:17008
    v_mfma_f32_16x16x32_bf16 v[140:143], v[56:59], v[28:31], v[140:143]
    ds_read_b64_tr_b16 v[50:51], v7 offset:17520
    s_waitcnt lgkmcnt(8)
    v_mfma_f32_16x16x32_bf16 v[144:147], v[32:35], v[24:27], v[144:147]
    ds_read_b64_tr_b16 v[52:53], v10 offset:16896
    v_mfma_f32_16x16x32_bf16 v[148:151], v[32:35], v[28:31], v[148:151]
    ds_read_b64_tr_b16 v[54:55], v10 offset:17408
    s_waitcnt lgkmcnt(8)
    v_mfma_f32_16x16x32_bf16 v[152:155], v[36:39], v[16:19], v[152:155]
    ds_read_b64_tr_b16 v[56:57], v11 offset:16896
    v_mfma_f32_16x16x32_bf16 v[156:159], v[36:39], v[20:23], v[156:159]
    ds_read_b64_tr_b16 v[58:59], v11 offset:17408
    v_cvt_pk_bf16_f32 v136, v136, v137
    v_cvt_pk_bf16_f32 v137, v138, v139
    v_cvt_pk_bf16_f32 v138, v140, v141
    v_cvt_pk_bf16_f32 v139, v142, v143
    s_add_u32 s3, s27, 303104
    s_add_u32 s3, s3, s21
    v_permlane16_swap_b32 v136, v138
    v_permlane16_swap_b32 v137, v139
    buffer_store_dwordx4 v[136:139], v12, s[12:15], s3 offen sc1
    s_waitcnt lgkmcnt(8)
    v_mfma_f32_16x16x32_bf16 v[160:163], v[40:43], v[16:19], v[160:163]
    v_mfma_f32_16x16x32_bf16 v[164:167], v[40:43], v[20:23], v[164:167]
    v_cvt_pk_bf16_f32 v144, v144, v145
    v_cvt_pk_bf16_f32 v145, v146, v147
    v_cvt_pk_bf16_f32 v146, v148, v149
    v_cvt_pk_bf16_f32 v147, v150, v151
    s_add_u32 s3, s27, 532480
    s_add_u32 s3, s3, s21
    v_permlane16_swap_b32 v144, v146
    v_permlane16_swap_b32 v145, v147
    buffer_store_dwordx4 v[144:147], v12, s[12:15], s3 offen sc1
    s_waitcnt lgkmcnt(6)
    v_mfma_f32_16x16x32_bf16 v[168:171], v[44:47], v[16:19], v[168:171]
    v_mfma_f32_16x16x32_bf16 v[172:175], v[44:47], v[20:23], v[172:175]
    s_waitcnt lgkmcnt(4)
    v_mfma_f32_16x16x32_bf16 v[152:155], v[48:51], v[24:27], v[152:155]
    v_mfma_f32_16x16x32_bf16 v[156:159], v[48:51], v[28:31], v[156:159]
    s_waitcnt lgkmcnt(2)
    v_mfma_f32_16x16x32_bf16 v[160:163], v[52:55], v[24:27], v[160:163]
    v_mfma_f32_16x16x32_bf16 v[164:167], v[52:55], v[28:31], v[164:167]
    s_waitcnt lgkmcnt(0)
    v_mfma_f32_16x16x32_bf16 v[168:171], v[56:59], v[24:27], v[168:171]
    v_mfma_f32_16x16x32_bf16 v[172:175], v[56:59], v[28:31], v[172:175]
    v_cvt_pk_bf16_f32 v152, v152, v153
    v_cvt_pk_bf16_f32 v153, v154, v155
    v_cvt_pk_bf16_f32 v154, v156, v157
    v_cvt_pk_bf16_f32 v155, v158, v159
    s_add_u32 s3, s27, 761856
    s_add_u32 s3, s3, s21
    v_permlane16_swap_b32 v152, v154
    v_permlane16_swap_b32 v153, v155
    buffer_store_dwordx4 v[152:155], v12, s[12:15], s3 offen sc1
    s_nop 7
    s_lshl_b32 s3, s24, 2
    s_add_u32 s3, s3, s26
    s_add_u32 s3, s3, 65536
    v_lshlrev_b32 v14, 2, v3
    v_add_u32 v14, v14, v13
    v_add_u32 v15, 229376, v14
    v_pk_mul_f32 v[160:161], v[160:161], s[22:23]
    v_pk_mul_f32 v[162:163], v[162:163], s[22:23]
    v_cvt_pk_bf16_f32 v160, v160, v161
    v_cvt_pk_bf16_f32 v161, v162, v163
    buffer_store_dword v160, v14, s[12:15], s3 offen offset:0
    buffer_store_dword v161, v15, s[12:15], s3 offen offset:0
    v_pk_mul_f32 v[164:165], v[164:165], s[22:23]
    v_pk_mul_f32 v[166:167], v[166:167], s[22:23]
    v_cvt_pk_bf16_f32 v164, v164, v165
    v_cvt_pk_bf16_f32 v165, v166, v167
    buffer_store_dword v164, v14, s[12:15], s3 offen offset:64
    buffer_store_dword v165, v15, s[12:15], s3 offen offset:64
    s_lshl_b32 s3, s24, 3
    s_add_u32 s3, s3, s27
    s_add_u32 s3, s3, 139264
    v_lshlrev_b32 v14, 3, v3
    v_add_u32 v14, v14, v13
    v_add_u32 v15, 229376, v14
    s_mov_b32 exec_hi, 0
    v_cvt_pk_bf16_f32 v168, v168, v169
    v_cvt_pk_bf16_f32 v170, v170, v171
    v_mov_b32 v169, 0x00003F80
    v_mov_b32 v171, 0x00003F80
    buffer_store_dwordx2 v[168:169], v14, s[12:15], s3 offen offset:0
    buffer_store_dwordx2 v[170:171], v15, s[12:15], s3 offen offset:0
    v_cvt_pk_bf16_f32 v172, v172, v173
    v_cvt_pk_bf16_f32 v174, v174, v175
    v_mov_b32 v173, 0x00003F80
    v_mov_b32 v175, 0x00003F80
    buffer_store_dwordx2 v[172:173], v14, s[12:15], s3 offen offset:128
    buffer_store_dwordx2 v[174:175], v15, s[12:15], s3 offen offset:128
    s_mov_b64 exec, -1
    s_branch K1_FIN
K1_EKK:
    s_waitcnt lgkmcnt(2)
    v_mfma_f32_16x16x32_bf16 v[64:67], v[32:35], v[16:19], v[64:67]
    ds_read_b64_tr_b16 v[52:53], v6 offset:16896
    ds_read_b64_tr_b16 v[54:55], v6 offset:17408
    v_mfma_f32_16x16x32_bf16 v[68:71], v[32:35], v[20:23], v[68:71]
    ds_read_b128 v[24:27], v5 offset:0
    ds_read_b128 v[28:31], v5 offset:2048
    s_waitcnt lgkmcnt(6)
    v_mfma_f32_16x16x32_bf16 v[72:75], v[36:39], v[16:19], v[72:75]
    ds_read_b64_tr_b16 v[56:57], v6 offset:16936
    v_mfma_f32_16x16x32_bf16 v[76:79], v[36:39], v[20:23], v[76:79]
    ds_read_b64_tr_b16 v[58:59], v6 offset:17448
    s_waitcnt lgkmcnt(8)
    v_mfma_f32_16x16x32_bf16 v[80:83], v[40:43], v[16:19], v[80:83]
    ds_read_b64_tr_b16 v[32:33], v6 offset:16968
    v_mfma_f32_16x16x32_bf16 v[84:87], v[40:43], v[20:23], v[84:87]
    ds_read_b64_tr_b16 v[34:35], v6 offset:17480
    s_waitcnt lgkmcnt(10)
    v_mfma_f32_16x16x32_bf16 v[88:91], v[44:47], v[16:19], v[88:91]
    ds_read_b64_tr_b16 v[36:37], v6 offset:17008
    v_mfma_f32_16x16x32_bf16 v[92:95], v[44:47], v[20:23], v[92:95]
    ds_read_b64_tr_b16 v[38:39], v6 offset:17520
    s_waitcnt lgkmcnt(10)
    v_mfma_f32_16x16x32_bf16 v[96:99], v[48:51], v[16:19], v[96:99]
    ds_read_b64_tr_b16 v[40:41], v6 offset:17040
    v_mfma_f32_16x16x32_bf16 v[100:103], v[48:51], v[20:23], v[100:103]
    ds_read_b64_tr_b16 v[42:43], v6 offset:17552
    s_waitcnt lgkmcnt(8)
    v_mfma_f32_16x16x32_bf16 v[64:67], v[52:55], v[24:27], v[64:67]
    ds_read_b64_tr_b16 v[44:45], v6 offset:184
    v_mfma_f32_16x16x32_bf16 v[68:71], v[52:55], v[28:31], v[68:71]
    ds_read_b64_tr_b16 v[46:47], v6 offset:696
    s_waitcnt lgkmcnt(8)
    v_mfma_f32_16x16x32_bf16 v[72:75], v[56:59], v[24:27], v[72:75]
    ds_read_b64_tr_b16 v[48:49], v6 offset:216
    v_mfma_f32_16x16x32_bf16 v[76:79], v[56:59], v[28:31], v[76:79]
    ds_read_b64_tr_b16 v[50:51], v6 offset:728
    s_waitcnt lgkmcnt(8)
    v_mfma_f32_16x16x32_bf16 v[80:83], v[32:35], v[24:27], v[80:83]
    ds_read_b64_tr_b16 v[52:53], v6 offset:17080
    v_mfma_f32_16x16x32_bf16 v[84:87], v[32:35], v[28:31], v[84:87]
    ds_read_b64_tr_b16 v[54:55], v6 offset:17592
    v_cvt_pk_bf16_f32 v64, v64, v65
    v_cvt_pk_bf16_f32 v65, v66, v67
    v_cvt_pk_bf16_f32 v66, v68, v69
    v_cvt_pk_bf16_f32 v67, v70, v71
    s_add_u32 s3, s26, 73728
    s_add_u32 s3, s3, s21
    v_permlane16_swap_b32 v64, v66
    v_permlane16_swap_b32 v65, v67
    buffer_store_dwordx4 v[64:67], v12, s[12:15], s3 offen sc1
    s_waitcnt lgkmcnt(8)
    v_mfma_f32_16x16x32_bf16 v[88:91], v[36:39], v[24:27], v[88:91]
    ds_read_b64_tr_b16 v[56:57], v6 offset:17112
    v_mfma_f32_16x16x32_bf16 v[92:95], v[36:39], v[28:31], v[92:95]
    ds_read_b64_tr_b16 v[58:59], v6 offset:17624
    v_cvt_pk_bf16_f32 v72, v72, v73
    v_cvt_pk_bf16_f32 v73, v74, v75
    v_cvt_pk_bf16_f32 v74, v76, v77
    v_cvt_pk_bf16_f32 v75, v78, v79
    s_add_u32 s3, s26, 303104
    s_add_u32 s3, s3, s21
    v_permlane16_swap_b32 v72, v74
    v_permlane16_swap_b32 v73, v75
    buffer_store_dwordx4 v[72:75], v12, s[12:15], s3 offen sc1
    s_waitcnt lgkmcnt(8)
    v_mfma_f32_16x16x32_bf16 v[96:99], v[40:43], v[24:27], v[96:99]
    ds_read_b64_tr_b16 v[32:33], v6 offset:256
    v_mfma_f32_16x16x32_bf16 v[100:103], v[40:43], v[28:31], v[100:103]
    ds_read_b64_tr_b16 v[34:35], v6 offset:768
    v_cvt_pk_bf16_f32 v80, v80, v81
    v_cvt_pk_bf16_f32 v81, v82, v83
    v_cvt_pk_bf16_f32 v82, v84, v85
    v_cvt_pk_bf16_f32 v83, v86, v87
    s_add_u32 s3, s26, 532480
    s_add_u32 s3, s3, s21
    v_permlane16_swap_b32 v80, v82
    v_permlane16_swap_b32 v81, v83
    buffer_store_dwordx4 v[80:83], v12, s[12:15], s3 offen sc1
    s_waitcnt lgkmcnt(8)
    v_mfma_f32_16x16x32_bf16 v[104:107], v[44:47], v[16:19], v[104:107]
    ds_read_b64_tr_b16 v[36:37], v7 offset:0
    v_mfma_f32_16x16x32_bf16 v[108:111], v[44:47], v[20:23], v[108:111]
    ds_read_b64_tr_b16 v[38:39], v7 offset:512
    v_cvt_pk_bf16_f32 v88, v88, v89
    v_cvt_pk_bf16_f32 v89, v90, v91
    v_cvt_pk_bf16_f32 v90, v92, v93
    v_cvt_pk_bf16_f32 v91, v94, v95
    s_add_u32 s3, s26, 761856
    s_add_u32 s3, s3, s21
    v_permlane16_swap_b32 v88, v90
    v_permlane16_swap_b32 v89, v91
    buffer_store_dwordx4 v[88:91], v12, s[12:15], s3 offen sc1
    s_waitcnt lgkmcnt(8)
    v_mfma_f32_16x16x32_bf16 v[112:115], v[48:51], v[16:19], v[112:115]
    ds_read_b64_tr_b16 v[40:41], v6 offset:17152
    v_mfma_f32_16x16x32_bf16 v[116:119], v[48:51], v[20:23], v[116:119]
    ds_read_b64_tr_b16 v[42:43], v6 offset:17664
    v_cvt_pk_bf16_f32 v96, v96, v97
    v_cvt_pk_bf16_f32 v97, v98, v99
    v_cvt_pk_bf16_f32 v98, v100, v101
    v_cvt_pk_bf16_f32 v99, v102, v103
    s_add_u32 s3, s26, 991232
    s_add_u32 s3, s3, s21
    v_permlane16_swap_b32 v96, v98
    v_permlane16_swap_b32 v97, v99
    buffer_store_dwordx4 v[96:99], v12, s[12:15], s3 offen sc1
    s_waitcnt lgkmcnt(8)
    v_mfma_f32_16x16x32_bf16 v[104:107], v[52:55], v[24:27], v[104:107]
    ds_read_b64_tr_b16 v[44:45], v7 offset:16896
    v_mfma_f32_16x16x32_bf16 v[108:111], v[52:55], v[28:31], v[108:111]
    ds_read_b64_tr_b16 v[46:47], v7 offset:17408
    s_waitcnt lgkmcnt(8)
    v_mfma_f32_16x16x32_bf16 v[112:115], v[56:59], v[24:27], v[112:115]
    ds_read_b64_tr_b16 v[48:49], v7 offset:40
    v_mfma_f32_16x16x32_bf16 v[116:119], v[56:59], v[28:31], v[116:119]
    ds_read_b64_tr_b16 v[50:51], v7 offset:552
    s_waitcnt lgkmcnt(8)
    v_mfma_f32_16x16x32_bf16 v[120:123], v[32:35], v[16:19], v[120:123]
    ds_read_b64_tr_b16 v[52:53], v7 offset:72
    v_mfma_f32_16x16x32_bf16 v[124:127], v[32:35], v[20:23], v[124:127]
    ds_read_b64_tr_b16 v[54:55], v7 offset:584
    v_cvt_pk_bf16_f32 v104, v104, v105
    v_cvt_pk_bf16_f32 v105, v106, v107
    v_cvt_pk_bf16_f32 v106, v108, v109
    v_cvt_pk_bf16_f32 v107, v110, v111
    s_add_u32 s3, s26, 1220608
    s_add_u32 s3, s3, s21
    v_permlane16_swap_b32 v104, v106
    v_permlane16_swap_b32 v105, v107
    buffer_store_dwordx4 v[104:107], v12, s[12:15], s3 offen sc1
    s_waitcnt lgkmcnt(8)
    v_mfma_f32_16x16x32_bf16 v[128:131], v[36:39], v[16:19], v[128:131]
    ds_read_b64_tr_b16 v[56:57], v7 offset:16936
    v_mfma_f32_16x16x32_bf16 v[132:135], v[36:39], v[20:23], v[132:135]
    ds_read_b64_tr_b16 v[58:59], v7 offset:17448
    v_cvt_pk_bf16_f32 v112, v112, v113
    v_cvt_pk_bf16_f32 v113, v114, v115
    v_cvt_pk_bf16_f32 v114, v116, v117
    v_cvt_pk_bf16_f32 v115, v118, v119
    s_add_u32 s3, s26, 1449984
    s_add_u32 s3, s3, s21
    v_permlane16_swap_b32 v112, v114
    v_permlane16_swap_b32 v113, v115
    buffer_store_dwordx4 v[112:115], v12, s[12:15], s3 offen sc1
    s_waitcnt lgkmcnt(8)
    v_mfma_f32_16x16x32_bf16 v[120:123], v[40:43], v[24:27], v[120:123]
    ds_read_b64_tr_b16 v[32:33], v7 offset:16968
    v_mfma_f32_16x16x32_bf16 v[124:127], v[40:43], v[28:31], v[124:127]
    ds_read_b64_tr_b16 v[34:35], v7 offset:17480
    s_waitcnt lgkmcnt(8)
    v_mfma_f32_16x16x32_bf16 v[128:131], v[44:47], v[24:27], v[128:131]
    ds_read_b64_tr_b16 v[36:37], v7 offset:112
    v_mfma_f32_16x16x32_bf16 v[132:135], v[44:47], v[28:31], v[132:135]
    ds_read_b64_tr_b16 v[38:39], v7 offset:624
    s_waitcnt lgkmcnt(8)
    v_mfma_f32_16x16x32_bf16 v[136:139], v[48:51], v[16:19], v[136:139]
    ds_read_b64_tr_b16 v[40:41], v10 offset:0
    v_mfma_f32_16x16x32_bf16 v[140:143], v[48:51], v[20:23], v[140:143]
    ds_read_b64_tr_b16 v[42:43], v10 offset:512
    v_cvt_pk_bf16_f32 v120, v120, v121
    v_cvt_pk_bf16_f32 v121, v122, v123
    v_cvt_pk_bf16_f32 v122, v124, v125
    v_cvt_pk_bf16_f32 v123, v126, v127
    s_add_u32 s3, s26, 1679360
    s_add_u32 s3, s3, s21
    v_permlane16_swap_b32 v120, v122
    v_permlane16_swap_b32 v121, v123
    buffer_store_dwordx4 v[120:123], v12, s[12:15], s3 offen sc1
    s_waitcnt lgkmcnt(8)
    v_mfma_f32_16x16x32_bf16 v[144:147], v[52:55], v[16:19], v[144:147]
    ds_read_b64_tr_b16 v[44:45], v11 offset:0
    v_mfma_f32_16x16x32_bf16 v[148:151], v[52:55], v[20:23], v[148:151]
    ds_read_b64_tr_b16 v[46:47], v11 offset:512
    v_cvt_pk_bf16_f32 v128, v128, v129
    v_cvt_pk_bf16_f32 v129, v130, v131
    v_cvt_pk_bf16_f32 v130, v132, v133
    v_cvt_pk_bf16_f32 v131, v134, v135
    s_add_u32 s3, s27, 73728
    s_add_u32 s3, s3, s21
    v_permlane16_swap_b32 v128, v130
    v_permlane16_swap_b32 v129, v131
    buffer_store_dwordx4 v[128:131], v12, s[12:15], s3 offen sc1
    s_waitcnt lgkmcnt(8)
    v_mfma_f32_16x16x32_bf16 v[136:139], v[56:59], v[24:27], v[136:139]
    ds_read_b64_tr_b16 v[48:49], v7 offset:17008
    v_mfma_f32_16x16x32_bf16 v[140:143], v[56:59], v[28:31], v[140:143]
    ds_read_b64_tr_b16 v[50:51], v7 offset:17520
    s_waitcnt lgkmcnt(8)
    v_mfma_f32_16x16x32_bf16 v[144:147], v[32:35], v[24:27], v[144:147]
    ds_read_b64_tr_b16 v[52:53], v10 offset:16896
    v_mfma_f32_16x16x32_bf16 v[148:151], v[32:35], v[28:31], v[148:151]
    ds_read_b64_tr_b16 v[54:55], v10 offset:17408
    s_waitcnt lgkmcnt(8)
    v_mfma_f32_16x16x32_bf16 v[152:155], v[36:39], v[16:19], v[152:155]
    ds_read_b64_tr_b16 v[56:57], v11 offset:16896
    v_mfma_f32_16x16x32_bf16 v[156:159], v[36:39], v[20:23], v[156:159]
    ds_read_b64_tr_b16 v[58:59], v11 offset:17408
    v_cvt_pk_bf16_f32 v136, v136, v137
    v_cvt_pk_bf16_f32 v137, v138, v139
    v_cvt_pk_bf16_f32 v138, v140, v141
    v_cvt_pk_bf16_f32 v139, v142, v143
    s_add_u32 s3, s27, 303104
    s_add_u32 s3, s3, s21
    v_permlane16_swap_b32 v136, v138
    v_permlane16_swap_b32 v137, v139
    buffer_store_dwordx4 v[136:139], v12, s[12:15], s3 offen sc1
    s_waitcnt lgkmcnt(8)
    v_mfma_f32_16x16x32_bf16 v[160:163], v[40:43], v[16:19], v[160:163]
    v_mfma_f32_16x16x32_bf16 v[164:167], v[40:43], v[20:23], v[164:167]
    v_cvt_pk_bf16_f32 v144, v144, v145
    v_cvt_pk_bf16_f32 v145, v146, v147
    v_cvt_pk_bf16_f32 v146, v148, v149
    v_cvt_pk_bf16_f32 v147, v150, v151
    s_add_u32 s3, s27, 532480
    s_add_u32 s3, s3, s21
    v_permlane16_swap_b32 v144, v146
    v_permlane16_swap_b32 v145, v147
    buffer_store_dwordx4 v[144:147], v12, s[12:15], s3 offen sc1
    s_waitcnt lgkmcnt(6)
    v_mfma_f32_16x16x32_bf16 v[168:171], v[44:47], v[16:19], v[168:171]
    v_mfma_f32_16x16x32_bf16 v[172:175], v[44:47], v[20:23], v[172:175]
    s_waitcnt lgkmcnt(4)
    v_mfma_f32_16x16x32_bf16 v[152:155], v[48:51], v[24:27], v[152:155]
    v_mfma_f32_16x16x32_bf16 v[156:159], v[48:51], v[28:31], v[156:159]
    s_waitcnt lgkmcnt(2)
    v_mfma_f32_16x16x32_bf16 v[160:163], v[52:55], v[24:27], v[160:163]
    v_mfma_f32_16x16x32_bf16 v[164:167], v[52:55], v[28:31], v[164:167]
    s_waitcnt lgkmcnt(0)
    v_mfma_f32_16x16x32_bf16 v[168:171], v[56:59], v[24:27], v[168:171]
    v_mfma_f32_16x16x32_bf16 v[172:175], v[56:59], v[28:31], v[172:175]
    v_cvt_pk_bf16_f32 v152, v152, v153
    v_cvt_pk_bf16_f32 v153, v154, v155
    v_cvt_pk_bf16_f32 v154, v156, v157
    v_cvt_pk_bf16_f32 v155, v158, v159
    s_add_u32 s3, s27, 761856
    s_add_u32 s3, s3, s21
    v_permlane16_swap_b32 v152, v154
    v_permlane16_swap_b32 v153, v155
    buffer_store_dwordx4 v[152:155], v12, s[12:15], s3 offen sc1
    s_nop 7
    s_lshl_b32 s3, s24, 3
    s_add_u32 s3, s3, s26
    s_add_u32 s3, s3, 139264
    v_lshlrev_b32 v14, 3, v3
    v_add_u32 v14, v14, v13
    v_add_u32 v15, 229376, v14
    v_cvt_pk_bf16_f32 v160, v160, v161
    v_cvt_pk_bf16_f32 v162, v162, v163
    v_mov_b32 v161, 0x00003F80
    v_mov_b32 v163, 0x00003F80
    buffer_store_dwordx2 v[160:161], v14, s[12:15], s3 offen offset:0
    buffer_store_dwordx2 v[162:163], v15, s[12:15], s3 offen offset:0
    v_cvt_pk_bf16_f32 v164, v164, v165
    v_cvt_pk_bf16_f32 v166, v166, v167
    v_mov_b32 v165, 0x00003F80
    v_mov_b32 v167, 0x00003F80
    buffer_store_dwordx2 v[164:165], v14, s[12:15], s3 offen offset:128
    buffer_store_dwordx2 v[166:167], v15, s[12:15], s3 offen offset:128
    s_lshl_b32 s3, s24, 3
    s_add_u32 s3, s3, s27
    s_add_u32 s3, s3, 139264
    v_lshlrev_b32 v14, 3, v3
    v_add_u32 v14, v14, v13
    v_add_u32 v15, 229376, v14
    s_mov_b32 exec_hi, 0
    v_cvt_pk_bf16_f32 v168, v168, v169
    v_cvt_pk_bf16_f32 v170, v170, v171
    v_mov_b32 v169, 0x00003F80
    v_mov_b32 v171, 0x00003F80
    buffer_store_dwordx2 v[168:169], v14, s[12:15], s3 offen offset:0
    buffer_store_dwordx2 v[170:171], v15, s[12:15], s3 offen offset:0
    v_cvt_pk_bf16_f32 v172, v172, v173
    v_cvt_pk_bf16_f32 v174, v174, v175
    v_mov_b32 v173, 0x00003F80
    v_mov_b32 v175, 0x00003F80
    buffer_store_dwordx2 v[172:173], v14, s[12:15], s3 offen offset:128
    buffer_store_dwordx2 v[174:175], v15, s[12:15], s3 offen offset:128
    s_mov_b64 exec, -1
    s_branch K1_FIN
K1_EVK:
    s_waitcnt lgkmcnt(2)
    v_mfma_f32_16x16x32_bf16 v[64:67], v[16:19], v[32:35], v[64:67]
    ds_read_b64_tr_b16 v[52:53], v6 offset:16896
    ds_read_b64_tr_b16 v[54:55], v6 offset:17408
    v_mfma_f32_16x16x32_bf16 v[68:71], v[20:23], v[32:35], v[68:71]
    ds_read_b128 v[24:27], v5 offset:0
    ds_read_b128 v[28:31], v5 offset:2048
    s_waitcnt lgkmcnt(6)
    v_mfma_f32_16x16x32_bf16 v[72:75], v[16:19], v[36:39], v[72:75]
    ds_read_b64_tr_b16 v[56:57], v6 offset:16936
    v_mfma_f32_16x16x32_bf16 v[76:79], v[20:23], v[36:39], v[76:79]
    ds_read_b64_tr_b16 v[58:59], v6 offset:17448
    s_waitcnt lgkmcnt(8)
    v_mfma_f32_16x16x32_bf16 v[80:83], v[16:19], v[40:43], v[80:83]
    ds_read_b64_tr_b16 v[32:33], v6 offset:16968
    v_mfma_f32_16x16x32_bf16 v[84:87], v[20:23], v[40:43], v[84:87]
    ds_read_b64_tr_b16 v[34:35], v6 offset:17480
    s_waitcnt lgkmcnt(10)
    v_mfma_f32_16x16x32_bf16 v[88:91], v[16:19], v[44:47], v[88:91]
    ds_read_b64_tr_b16 v[36:37], v6 offset:17008
    v_mfma_f32_16x16x32_bf16 v[92:95], v[20:23], v[44:47], v[92:95]
    ds_read_b64_tr_b16 v[38:39], v6 offset:17520
    s_waitcnt lgkmcnt(10)
    v_mfma_f32_16x16x32_bf16 v[96:99], v[16:19], v[48:51], v[96:99]
    ds_read_b64_tr_b16 v[40:41], v6 offset:17040
    v_mfma_f32_16x16x32_bf16 v[100:103], v[20:23], v[48:51], v[100:103]
    ds_read_b64_tr_b16 v[42:43], v6 offset:17552
    s_waitcnt lgkmcnt(8)
    v_mfma_f32_16x16x32_bf16 v[64:67], v[24:27], v[52:55], v[64:67]
    ds_read_b64_tr_b16 v[44:45], v6 offset:184
    v_mfma_f32_16x16x32_bf16 v[68:71], v[28:31], v[52:55], v[68:71]
    ds_read_b64_tr_b16 v[46:47], v6 offset:696
    s_waitcnt lgkmcnt(8)
    v_mfma_f32_16x16x32_bf16 v[72:75], v[24:27], v[56:59], v[72:75]
    ds_read_b64_tr_b16 v[48:49], v6 offset:216
    v_mfma_f32_16x16x32_bf16 v[76:79], v[28:31], v[56:59], v[76:79]
    ds_read_b64_tr_b16 v[50:51], v6 offset:728
    s_waitcnt lgkmcnt(8)
    v_mfma_f32_16x16x32_bf16 v[80:83], v[24:27], v[32:35], v[80:83]
    ds_read_b64_tr_b16 v[52:53], v6 offset:17080
    v_mfma_f32_16x16x32_bf16 v[84:87], v[28:31], v[32:35], v[84:87]
    ds_read_b64_tr_b16 v[54:55], v6 offset:17592
    v_cvt_pk_bf16_f32 v64, v64, v65
    v_cvt_pk_bf16_f32 v65, v66, v67
    v_cvt_pk_bf16_f32 v66, v68, v69
    v_cvt_pk_bf16_f32 v67, v70, v71
    s_add_u32 s3, s26, 0
    s_add_u32 s3, s3, s25
    v_permlane16_swap_b32 v64, v66
    v_permlane16_swap_b32 v65, v67
    buffer_store_dwordx4 v[64:67], v8, s[12:15], s3 offen sc1
    s_waitcnt lgkmcnt(8)
    v_mfma_f32_16x16x32_bf16 v[88:91], v[24:27], v[36:39], v[88:91]
    ds_read_b64_tr_b16 v[56:57], v6 offset:17112
    v_mfma_f32_16x16x32_bf16 v[92:95], v[28:31], v[36:39], v[92:95]
    ds_read_b64_tr_b16 v[58:59], v6 offset:17624
    v_cvt_pk_bf16_f32 v72, v72, v73
    v_cvt_pk_bf16_f32 v73, v74, v75
    v_cvt_pk_bf16_f32 v74, v76, v77
    v_cvt_pk_bf16_f32 v75, v78, v79
    s_add_u32 s3, s26, 229408
    s_add_u32 s3, s3, s25
    v_permlane16_swap_b32 v72, v74
    v_permlane16_swap_b32 v73, v75
    buffer_store_dwordx4 v[72:75], v8, s[12:15], s3 offen sc1
    s_waitcnt lgkmcnt(8)
    v_mfma_f32_16x16x32_bf16 v[96:99], v[24:27], v[40:43], v[96:99]
    ds_read_b64_tr_b16 v[32:33], v6 offset:256
    v_mfma_f32_16x16x32_bf16 v[100:103], v[28:31], v[40:43], v[100:103]
    ds_read_b64_tr_b16 v[34:35], v6 offset:768
    v_cvt_pk_bf16_f32 v80, v80, v81
    v_cvt_pk_bf16_f32 v81, v82, v83
    v_cvt_pk_bf16_f32 v82, v84, v85
    v_cvt_pk_bf16_f32 v83, v86, v87
    s_add_u32 s3, s26, 458752
    s_add_u32 s3, s3, s25
    v_permlane16_swap_b32 v80, v82
    v_permlane16_swap_b32 v81, v83
    buffer_store_dwordx4 v[80:83], v8, s[12:15], s3 offen sc1
    s_waitcnt lgkmcnt(8)
    v_mfma_f32_16x16x32_bf16 v[104:107], v[16:19], v[44:47], v[104:107]
    ds_read_b64_tr_b16 v[36:37], v7 offset:0
    v_mfma_f32_16x16x32_bf16 v[108:111], v[20:23], v[44:47], v[108:111]
    ds_read_b64_tr_b16 v[38:39], v7 offset:512
    v_cvt_pk_bf16_f32 v88, v88, v89
    v_cvt_pk_bf16_f32 v89, v90, v91
    v_cvt_pk_bf16_f32 v90, v92, v93
    v_cvt_pk_bf16_f32 v91, v94, v95
    s_add_u32 s3, s26, 688160
    s_add_u32 s3, s3, s25
    v_permlane16_swap_b32 v88, v90
    v_permlane16_swap_b32 v89, v91
    buffer_store_dwordx4 v[88:91], v8, s[12:15], s3 offen sc1
    s_waitcnt lgkmcnt(8)
    v_mfma_f32_16x16x32_bf16 v[112:115], v[16:19], v[48:51], v[112:115]
    ds_read_b64_tr_b16 v[40:41], v6 offset:17152
    v_mfma_f32_16x16x32_bf16 v[116:119], v[20:23], v[48:51], v[116:119]
    ds_read_b64_tr_b16 v[42:43], v6 offset:17664
    v_cvt_pk_bf16_f32 v96, v96, v97
    v_cvt_pk_bf16_f32 v97, v98, v99
    v_cvt_pk_bf16_f32 v98, v100, v101
    v_cvt_pk_bf16_f32 v99, v102, v103
    s_add_u32 s3, s26, 917504
    s_add_u32 s3, s3, s25
    v_permlane16_swap_b32 v96, v98
    v_permlane16_swap_b32 v97, v99
    buffer_store_dwordx4 v[96:99], v8, s[12:15], s3 offen sc1
    s_waitcnt lgkmcnt(8)
    v_mfma_f32_16x16x32_bf16 v[104:107], v[24:27], v[52:55], v[104:107]
    ds_read_b64_tr_b16 v[44:45], v7 offset:16896
    v_mfma_f32_16x16x32_bf16 v[108:111], v[28:31], v[52:55], v[108:111]
    ds_read_b64_tr_b16 v[46:47], v7 offset:17408
    s_waitcnt lgkmcnt(8)
    v_mfma_f32_16x16x32_bf16 v[112:115], v[24:27], v[56:59], v[112:115]
    ds_read_b64_tr_b16 v[48:49], v7 offset:40
    v_mfma_f32_16x16x32_bf16 v[116:119], v[28:31], v[56:59], v[116:119]
    ds_read_b64_tr_b16 v[50:51], v7 offset:552
    s_waitcnt lgkmcnt(8)
    v_mfma_f32_16x16x32_bf16 v[120:123], v[16:19], v[32:35], v[120:123]
    ds_read_b64_tr_b16 v[52:53], v7 offset:72
    v_mfma_f32_16x16x32_bf16 v[124:127], v[20:23], v[32:35], v[124:127]
    ds_read_b64_tr_b16 v[54:55], v7 offset:584
    v_cvt_pk_bf16_f32 v104, v104, v105
    v_cvt_pk_bf16_f32 v105, v106, v107
    v_cvt_pk_bf16_f32 v106, v108, v109
    v_cvt_pk_bf16_f32 v107, v110, v111
    s_add_u32 s3, s26, 1146912
    s_add_u32 s3, s3, s25
    v_permlane16_swap_b32 v104, v106
    v_permlane16_swap_b32 v105, v107
    buffer_store_dwordx4 v[104:107], v8, s[12:15], s3 offen sc1
    s_waitcnt lgkmcnt(8)
    v_mfma_f32_16x16x32_bf16 v[128:131], v[36:39], v[16:19], v[128:131]
    ds_read_b64_tr_b16 v[56:57], v7 offset:16936
    v_mfma_f32_16x16x32_bf16 v[132:135], v[36:39], v[20:23], v[132:135]
    ds_read_b64_tr_b16 v[58:59], v7 offset:17448
    v_cvt_pk_bf16_f32 v112, v112, v113
    v_cvt_pk_bf16_f32 v113, v114, v115
    v_cvt_pk_bf16_f32 v114, v116, v117
    v_cvt_pk_bf16_f32 v115, v118, v119
    s_add_u32 s3, s26, 1376256
    s_add_u32 s3, s3, s25
    v_permlane16_swap_b32 v112, v114
    v_permlane16_swap_b32 v113, v115
    buffer_store_dwordx4 v[112:115], v8, s[12:15], s3 offen sc1
    s_waitcnt lgkmcnt(8)
    v_mfma_f32_16x16x32_bf16 v[120:123], v[24:27], v[40:43], v[120:123]
    ds_read_b64_tr_b16 v[32:33], v7 offset:16968
    v_mfma_f32_16x16x32_bf16 v[124:127], v[28:31], v[40:43], v[124:127]
    ds_read_b64_tr_b16 v[34:35], v7 offset:17480
    s_waitcnt lgkmcnt(8)
    v_mfma_f32_16x16x32_bf16 v[128:131], v[44:47], v[24:27], v[128:131]
    ds_read_b64_tr_b16 v[36:37], v7 offset:112
    v_mfma_f32_16x16x32_bf16 v[132:135], v[44:47], v[28:31], v[132:135]
    ds_read_b64_tr_b16 v[38:39], v7 offset:624
    s_waitcnt lgkmcnt(8)
    v_mfma_f32_16x16x32_bf16 v[136:139], v[48:51], v[16:19], v[136:139]
    ds_read_b64_tr_b16 v[40:41], v10 offset:0
    v_mfma_f32_16x16x32_bf16 v[140:143], v[48:51], v[20:23], v[140:143]
    ds_read_b64_tr_b16 v[42:43], v10 offset:512
    v_cvt_pk_bf16_f32 v120, v120, v121
    v_cvt_pk_bf16_f32 v121, v122, v123
    v_cvt_pk_bf16_f32 v122, v124, v125
    v_cvt_pk_bf16_f32 v123, v126, v127
    s_add_u32 s3, s26, 1605664
    s_add_u32 s3, s3, s25
    v_permlane16_swap_b32 v120, v122
    v_permlane16_swap_b32 v121, v123
    buffer_store_dwordx4 v[120:123], v8, s[12:15], s3 offen sc1
    s_waitcnt lgkmcnt(8)
    v_mfma_f32_16x16x32_bf16 v[144:147], v[52:55], v[16:19], v[144:147]
    ds_read_b64_tr_b16 v[44:45], v11 offset:0
    v_mfma_f32_16x16x32_bf16 v[148:151], v[52:55], v[20:23], v[148:151]
    ds_read_b64_tr_b16 v[46:47], v11 offset:512
    v_cvt_pk_bf16_f32 v128, v128, v129
    v_cvt_pk_bf16_f32 v129, v130, v131
    v_cvt_pk_bf16_f32 v130, v132, v133
    v_cvt_pk_bf16_f32 v131, v134, v135
    s_add_u32 s3, s27, 73728
    s_add_u32 s3, s3, s21
    v_permlane16_swap_b32 v128, v130
    v_permlane16_swap_b32 v129, v131
    buffer_store_dwordx4 v[128:131], v12, s[12:15], s3 offen sc1
    s_waitcnt lgkmcnt(8)
    v_mfma_f32_16x16x32_bf16 v[136:139], v[56:59], v[24:27], v[136:139]
    ds_read_b64_tr_b16 v[48:49], v7 offset:17008
    v_mfma_f32_16x16x32_bf16 v[140:143], v[56:59], v[28:31], v[140:143]
    ds_read_b64_tr_b16 v[50:51], v7 offset:17520
    s_waitcnt lgkmcnt(8)
    v_mfma_f32_16x16x32_bf16 v[144:147], v[32:35], v[24:27], v[144:147]
    ds_read_b64_tr_b16 v[52:53], v10 offset:16896
    v_mfma_f32_16x16x32_bf16 v[148:151], v[32:35], v[28:31], v[148:151]
    ds_read_b64_tr_b16 v[54:55], v10 offset:17408
    s_waitcnt lgkmcnt(8)
    v_mfma_f32_16x16x32_bf16 v[152:155], v[36:39], v[16:19], v[152:155]
    ds_read_b64_tr_b16 v[56:57], v11 offset:16896
    v_mfma_f32_16x16x32_bf16 v[156:159], v[36:39], v[20:23], v[156:159]
    ds_read_b64_tr_b16 v[58:59], v11 offset:17408
    v_cvt_pk_bf16_f32 v136, v136, v137
    v_cvt_pk_bf16_f32 v137, v138, v139
    v_cvt_pk_bf16_f32 v138, v140, v141
    v_cvt_pk_bf16_f32 v139, v142, v143
    s_add_u32 s3, s27, 303104
    s_add_u32 s3, s3, s21
    v_permlane16_swap_b32 v136, v138
    v_permlane16_swap_b32 v137, v139
    buffer_store_dwordx4 v[136:139], v12, s[12:15], s3 offen sc1
    s_waitcnt lgkmcnt(8)
    v_mfma_f32_16x16x32_bf16 v[160:163], v[16:19], v[40:43], v[160:163]
    v_mfma_f32_16x16x32_bf16 v[164:167], v[20:23], v[40:43], v[164:167]
    v_cvt_pk_bf16_f32 v144, v144, v145
    v_cvt_pk_bf16_f32 v145, v146, v147
    v_cvt_pk_bf16_f32 v146, v148, v149
    v_cvt_pk_bf16_f32 v147, v150, v151
    s_add_u32 s3, s27, 532480
    s_add_u32 s3, s3, s21
    v_permlane16_swap_b32 v144, v146
    v_permlane16_swap_b32 v145, v147
    buffer_store_dwordx4 v[144:147], v12, s[12:15], s3 offen sc1
    s_waitcnt lgkmcnt(6)
    v_mfma_f32_16x16x32_bf16 v[168:171], v[44:47], v[16:19], v[168:171]
    v_mfma_f32_16x16x32_bf16 v[172:175], v[44:47], v[20:23], v[172:175]
    s_waitcnt lgkmcnt(4)
    v_mfma_f32_16x16x32_bf16 v[152:155], v[48:51], v[24:27], v[152:155]
    v_mfma_f32_16x16x32_bf16 v[156:159], v[48:51], v[28:31], v[156:159]
    s_waitcnt lgkmcnt(2)
    v_mfma_f32_16x16x32_bf16 v[160:163], v[24:27], v[52:55], v[160:163]
    v_mfma_f32_16x16x32_bf16 v[164:167], v[28:31], v[52:55], v[164:167]
    s_waitcnt lgkmcnt(0)
    v_mfma_f32_16x16x32_bf16 v[168:171], v[56:59], v[24:27], v[168:171]
    v_mfma_f32_16x16x32_bf16 v[172:175], v[56:59], v[28:31], v[172:175]
    v_cvt_pk_bf16_f32 v152, v152, v153
    v_cvt_pk_bf16_f32 v153, v154, v155
    v_cvt_pk_bf16_f32 v154, v156, v157
    v_cvt_pk_bf16_f32 v155, v158, v159
    s_add_u32 s3, s27, 761856
    s_add_u32 s3, s3, s21
    v_permlane16_swap_b32 v152, v154
    v_permlane16_swap_b32 v153, v155
    buffer_store_dwordx4 v[152:155], v12, s[12:15], s3 offen sc1
    s_nop 7
    v_cvt_pk_bf16_f32 v160, v160, v161
    v_cvt_pk_bf16_f32 v161, v162, v163
    v_cvt_pk_bf16_f32 v162, v164, v165
    v_cvt_pk_bf16_f32 v163, v166, v167
    s_add_u32 s3, s26, s25
    s_nop 0
    v_permlane16_swap_b32 v160, v162
    v_permlane16_swap_b32 v161, v163
    buffer_store_dwordx4 v[160:163], v9, s[12:15], s3 offen
    s_lshl_b32 s3, s24, 3
    s_add_u32 s3, s3, s27
    s_add_u32 s3, s3, 139264
    v_lshlrev_b32 v14, 3, v3
    v_add_u32 v14, v14, v13
    v_add_u32 v15, 229376, v14
    s_mov_b32 exec_hi, 0
    v_cvt_pk_bf16_f32 v168, v168, v169
    v_cvt_pk_bf16_f32 v170, v170, v171
    v_mov_b32 v169, 0x00003F80
    v_mov_b32 v171, 0x00003F80
    buffer_store_dwordx2 v[168:169], v14, s[12:15], s3 offen offset:0
    buffer_store_dwordx2 v[170:171], v15, s[12:15], s3 offen offset:0
    v_cvt_pk_bf16_f32 v172, v172, v173
    v_cvt_pk_bf16_f32 v174, v174, v175
    v_mov_b32 v173, 0x00003F80
    v_mov_b32 v175, 0x00003F80
    buffer_store_dwordx2 v[172:173], v14, s[12:15], s3 offen offset:128
    buffer_store_dwordx2 v[174:175], v15, s[12:15], s3 offen offset:128
    s_mov_b64 exec, -1
    s_branch K1_FIN
K1_EVV:
    s_waitcnt lgkmcnt(2)
    v_mfma_f32_16x16x32_bf16 v[64:67], v[16:19], v[32:35], v[64:67]
    ds_read_b64_tr_b16 v[52:53], v6 offset:16896
    ds_read_b64_tr_b16 v[54:55], v6 offset:17408
    v_mfma_f32_16x16x32_bf16 v[68:71], v[20:23], v[32:35], v[68:71]
    ds_read_b128 v[24:27], v5 offset:0
    ds_read_b128 v[28:31], v5 offset:2048
    s_waitcnt lgkmcnt(6)
    v_mfma_f32_16x16x32_bf16 v[72:75], v[16:19], v[36:39], v[72:75]
    ds_read_b64_tr_b16 v[56:57], v6 offset:16936
    v_mfma_f32_16x16x32_bf16 v[76:79], v[20:23], v[36:39], v[76:79]
    ds_read_b64_tr_b16 v[58:59], v6 offset:17448
    s_waitcnt lgkmcnt(8)
    v_mfma_f32_16x16x32_bf16 v[80:83], v[16:19], v[40:43], v[80:83]
    ds_read_b64_tr_b16 v[32:33], v6 offset:16968
    v_mfma_f32_16x16x32_bf16 v[84:87], v[20:23], v[40:43], v[84:87]
    ds_read_b64_tr_b16 v[34:35], v6 offset:17480
    s_waitcnt lgkmcnt(10)
    v_mfma_f32_16x16x32_bf16 v[88:91], v[16:19], v[44:47], v[88:91]
    ds_read_b64_tr_b16 v[36:37], v6 offset:17008
    v_mfma_f32_16x16x32_bf16 v[92:95], v[20:23], v[44:47], v[92:95]
    ds_read_b64_tr_b16 v[38:39], v6 offset:17520
    s_waitcnt lgkmcnt(10)
    v_mfma_f32_16x16x32_bf16 v[96:99], v[16:19], v[48:51], v[96:99]
    ds_read_b64_tr_b16 v[40:41], v6 offset:17040
    v_mfma_f32_16x16x32_bf16 v[100:103], v[20:23], v[48:51], v[100:103]
    ds_read_b64_tr_b16 v[42:43], v6 offset:17552
    s_waitcnt lgkmcnt(8)
    v_mfma_f32_16x16x32_bf16 v[64:67], v[24:27], v[52:55], v[64:67]
    ds_read_b64_tr_b16 v[44:45], v6 offset:184
    v_mfma_f32_16x16x32_bf16 v[68:71], v[28:31], v[52:55], v[68:71]
    ds_read_b64_tr_b16 v[46:47], v6 offset:696
    s_waitcnt lgkmcnt(8)
    v_mfma_f32_16x16x32_bf16 v[72:75], v[24:27], v[56:59], v[72:75]
    ds_read_b64_tr_b16 v[48:49], v6 offset:216
    v_mfma_f32_16x16x32_bf16 v[76:79], v[28:31], v[56:59], v[76:79]
    ds_read_b64_tr_b16 v[50:51], v6 offset:728
    s_waitcnt lgkmcnt(8)
    v_mfma_f32_16x16x32_bf16 v[80:83], v[24:27], v[32:35], v[80:83]
    ds_read_b64_tr_b16 v[52:53], v6 offset:17080
    v_mfma_f32_16x16x32_bf16 v[84:87], v[28:31], v[32:35], v[84:87]
    ds_read_b64_tr_b16 v[54:55], v6 offset:17592
    v_cvt_pk_bf16_f32 v64, v64, v65
    v_cvt_pk_bf16_f32 v65, v66, v67
    v_cvt_pk_bf16_f32 v66, v68, v69
    v_cvt_pk_bf16_f32 v67, v70, v71
    s_add_u32 s3, s26, 0
    s_add_u32 s3, s3, s25
    v_permlane16_swap_b32 v64, v66
    v_permlane16_swap_b32 v65, v67
    buffer_store_dwordx4 v[64:67], v8, s[12:15], s3 offen sc1
    s_waitcnt lgkmcnt(8)
    v_mfma_f32_16x16x32_bf16 v[88:91], v[24:27], v[36:39], v[88:91]
    ds_read_b64_tr_b16 v[56:57], v6 offset:17112
    v_mfma_f32_16x16x32_bf16 v[92:95], v[28:31], v[36:39], v[92:95]
    ds_read_b64_tr_b16 v[58:59], v6 offset:17624
    v_cvt_pk_bf16_f32 v72, v72, v73
    v_cvt_pk_bf16_f32 v73, v74, v75
    v_cvt_pk_bf16_f32 v74, v76, v77
    v_cvt_pk_bf16_f32 v75, v78, v79
    s_add_u32 s3, s26, 229408
    s_add_u32 s3, s3, s25
    v_permlane16_swap_b32 v72, v74
    v_permlane16_swap_b32 v73, v75
    buffer_store_dwordx4 v[72:75], v8, s[12:15], s3 offen sc1
    s_waitcnt lgkmcnt(8)
    v_mfma_f32_16x16x32_bf16 v[96:99], v[24:27], v[40:43], v[96:99]
    ds_read_b64_tr_b16 v[32:33], v6 offset:256
    v_mfma_f32_16x16x32_bf16 v[100:103], v[28:31], v[40:43], v[100:103]
    ds_read_b64_tr_b16 v[34:35], v6 offset:768
    v_cvt_pk_bf16_f32 v80, v80, v81
    v_cvt_pk_bf16_f32 v81, v82, v83
    v_cvt_pk_bf16_f32 v82, v84, v85
    v_cvt_pk_bf16_f32 v83, v86, v87
    s_add_u32 s3, s26, 458752
    s_add_u32 s3, s3, s25
    v_permlane16_swap_b32 v80, v82
    v_permlane16_swap_b32 v81, v83
    buffer_store_dwordx4 v[80:83], v8, s[12:15], s3 offen sc1
    s_waitcnt lgkmcnt(8)
    v_mfma_f32_16x16x32_bf16 v[104:107], v[16:19], v[44:47], v[104:107]
    ds_read_b64_tr_b16 v[36:37], v7 offset:0
    v_mfma_f32_16x16x32_bf16 v[108:111], v[20:23], v[44:47], v[108:111]
    ds_read_b64_tr_b16 v[38:39], v7 offset:512
    v_cvt_pk_bf16_f32 v88, v88, v89
    v_cvt_pk_bf16_f32 v89, v90, v91
    v_cvt_pk_bf16_f32 v90, v92, v93
    v_cvt_pk_bf16_f32 v91, v94, v95
    s_add_u32 s3, s26, 688160
    s_add_u32 s3, s3, s25
    v_permlane16_swap_b32 v88, v90
    v_permlane16_swap_b32 v89, v91
    buffer_store_dwordx4 v[88:91], v8, s[12:15], s3 offen sc1
    s_waitcnt lgkmcnt(8)
    v_mfma_f32_16x16x32_bf16 v[112:115], v[16:19], v[48:51], v[112:115]
    ds_read_b64_tr_b16 v[40:41], v6 offset:17152
    v_mfma_f32_16x16x32_bf16 v[116:119], v[20:23], v[48:51], v[116:119]
    ds_read_b64_tr_b16 v[42:43], v6 offset:17664
    v_cvt_pk_bf16_f32 v96, v96, v97
    v_cvt_pk_bf16_f32 v97, v98, v99
    v_cvt_pk_bf16_f32 v98, v100, v101
    v_cvt_pk_bf16_f32 v99, v102, v103
    s_add_u32 s3, s26, 917504
    s_add_u32 s3, s3, s25
    v_permlane16_swap_b32 v96, v98
    v_permlane16_swap_b32 v97, v99
    buffer_store_dwordx4 v[96:99], v8, s[12:15], s3 offen sc1
    s_waitcnt lgkmcnt(8)
    v_mfma_f32_16x16x32_bf16 v[104:107], v[24:27], v[52:55], v[104:107]
    ds_read_b64_tr_b16 v[44:45], v7 offset:16896
    v_mfma_f32_16x16x32_bf16 v[108:111], v[28:31], v[52:55], v[108:111]
    ds_read_b64_tr_b16 v[46:47], v7 offset:17408
    s_waitcnt lgkmcnt(8)
    v_mfma_f32_16x16x32_bf16 v[112:115], v[24:27], v[56:59], v[112:115]
    ds_read_b64_tr_b16 v[48:49], v7 offset:40
    v_mfma_f32_16x16x32_bf16 v[116:119], v[28:31], v[56:59], v[116:119]
    ds_read_b64_tr_b16 v[50:51], v7 offset:552
    s_waitcnt lgkmcnt(8)
    v_mfma_f32_16x16x32_bf16 v[120:123], v[16:19], v[32:35], v[120:123]
    ds_read_b64_tr_b16 v[52:53], v7 offset:72
    v_mfma_f32_16x16x32_bf16 v[124:127], v[20:23], v[32:35], v[124:127]
    ds_read_b64_tr_b16 v[54:55], v7 offset:584
    v_cvt_pk_bf16_f32 v104, v104, v105
    v_cvt_pk_bf16_f32 v105, v106, v107
    v_cvt_pk_bf16_f32 v106, v108, v109
    v_cvt_pk_bf16_f32 v107, v110, v111
    s_add_u32 s3, s26, 1146912
    s_add_u32 s3, s3, s25
    v_permlane16_swap_b32 v104, v106
    v_permlane16_swap_b32 v105, v107
    buffer_store_dwordx4 v[104:107], v8, s[12:15], s3 offen sc1
    s_waitcnt lgkmcnt(8)
    v_mfma_f32_16x16x32_bf16 v[128:131], v[16:19], v[36:39], v[128:131]
    ds_read_b64_tr_b16 v[56:57], v7 offset:16936
    v_mfma_f32_16x16x32_bf16 v[132:135], v[20:23], v[36:39], v[132:135]
    ds_read_b64_tr_b16 v[58:59], v7 offset:17448
    v_cvt_pk_bf16_f32 v112, v112, v113
    v_cvt_pk_bf16_f32 v113, v114, v115
    v_cvt_pk_bf16_f32 v114, v116, v117
    v_cvt_pk_bf16_f32 v115, v118, v119
    s_add_u32 s3, s26, 1376256
    s_add_u32 s3, s3, s25
    v_permlane16_swap_b32 v112, v114
    v_permlane16_swap_b32 v113, v115
    buffer_store_dwordx4 v[112:115], v8, s[12:15], s3 offen sc1
    s_waitcnt lgkmcnt(8)
    v_mfma_f32_16x16x32_bf16 v[120:123], v[24:27], v[40:43], v[120:123]
    ds_read_b64_tr_b16 v[32:33], v7 offset:16968
    v_mfma_f32_16x16x32_bf16 v[124:127], v[28:31], v[40:43], v[124:127]
    ds_read_b64_tr_b16 v[34:35], v7 offset:17480
    s_waitcnt lgkmcnt(8)
    v_mfma_f32_16x16x32_bf16 v[128:131], v[24:27], v[44:47], v[128:131]
    ds_read_b64_tr_b16 v[36:37], v7 offset:112
    v_mfma_f32_16x16x32_bf16 v[132:135], v[28:31], v[44:47], v[132:135]
    ds_read_b64_tr_b16 v[38:39], v7 offset:624
    s_waitcnt lgkmcnt(8)
    v_mfma_f32_16x16x32_bf16 v[136:139], v[16:19], v[48:51], v[136:139]
    ds_read_b64_tr_b16 v[40:41], v10 offset:0
    v_mfma_f32_16x16x32_bf16 v[140:143], v[20:23], v[48:51], v[140:143]
    ds_read_b64_tr_b16 v[42:43], v10 offset:512
    v_cvt_pk_bf16_f32 v120, v120, v121
    v_cvt_pk_bf16_f32 v121, v122, v123
    v_cvt_pk_bf16_f32 v122, v124, v125
    v_cvt_pk_bf16_f32 v123, v126, v127
    s_add_u32 s3, s26, 1605664
    s_add_u32 s3, s3, s25
    v_permlane16_swap_b32 v120, v122
    v_permlane16_swap_b32 v121, v123
    buffer_store_dwordx4 v[120:123], v8, s[12:15], s3 offen sc1
    s_waitcnt lgkmcnt(8)
    v_mfma_f32_16x16x32_bf16 v[144:147], v[16:19], v[52:55], v[144:147]
    ds_read_b64_tr_b16 v[44:45], v11 offset:0
    v_mfma_f32_16x16x32_bf16 v[148:151], v[20:23], v[52:55], v[148:151]
    ds_read_b64_tr_b16 v[46:47], v11 offset:512
    v_cvt_pk_bf16_f32 v128, v128, v129
    v_cvt_pk_bf16_f32 v129, v130, v131
    v_cvt_pk_bf16_f32 v130, v132, v133
    v_cvt_pk_bf16_f32 v131, v134, v135
    s_add_u32 s3, s27, 0
    s_add_u32 s3, s3, s25
    v_permlane16_swap_b32 v128, v130
    v_permlane16_swap_b32 v129, v131
    buffer_store_dwordx4 v[128:131], v8, s[12:15], s3 offen sc1
    s_waitcnt lgkmcnt(8)
    v_mfma_f32_16x16x32_bf16 v[136:139], v[24:27], v[56:59], v[136:139]
    ds_read_b64_tr_b16 v[48:49], v7 offset:17008
    v_mfma_f32_16x16x32_bf16 v[140:143], v[28:31], v[56:59], v[140:143]
    ds_read_b64_tr_b16 v[50:51], v7 offset:17520
    s_waitcnt lgkmcnt(8)
    v_mfma_f32_16x16x32_bf16 v[144:147], v[24:27], v[32:35], v[144:147]
    ds_read_b64_tr_b16 v[52:53], v10 offset:16896
    v_mfma_f32_16x16x32_bf16 v[148:151], v[28:31], v[32:35], v[148:151]
    ds_read_b64_tr_b16 v[54:55], v10 offset:17408
    s_waitcnt lgkmcnt(8)
    v_mfma_f32_16x16x32_bf16 v[152:155], v[16:19], v[36:39], v[152:155]
    ds_read_b64_tr_b16 v[56:57], v11 offset:16896
    v_mfma_f32_16x16x32_bf16 v[156:159], v[20:23], v[36:39], v[156:159]
    ds_read_b64_tr_b16 v[58:59], v11 offset:17408
    v_cvt_pk_bf16_f32 v136, v136, v137
    v_cvt_pk_bf16_f32 v137, v138, v139
    v_cvt_pk_bf16_f32 v138, v140, v141
    v_cvt_pk_bf16_f32 v139, v142, v143
    s_add_u32 s3, s27, 229408
    s_add_u32 s3, s3, s25
    v_permlane16_swap_b32 v136, v138
    v_permlane16_swap_b32 v137, v139
    buffer_store_dwordx4 v[136:139], v8, s[12:15], s3 offen sc1
    s_waitcnt lgkmcnt(8)
    v_mfma_f32_16x16x32_bf16 v[160:163], v[16:19], v[40:43], v[160:163]
    v_mfma_f32_16x16x32_bf16 v[164:167], v[20:23], v[40:43], v[164:167]
    v_cvt_pk_bf16_f32 v144, v144, v145
    v_cvt_pk_bf16_f32 v145, v146, v147
    v_cvt_pk_bf16_f32 v146, v148, v149
    v_cvt_pk_bf16_f32 v147, v150, v151
    s_add_u32 s3, s27, 458752
    s_add_u32 s3, s3, s25
    v_permlane16_swap_b32 v144, v146
    v_permlane16_swap_b32 v145, v147
    buffer_store_dwordx4 v[144:147], v8, s[12:15], s3 offen sc1
    s_waitcnt lgkmcnt(6)
    v_mfma_f32_16x16x32_bf16 v[168:171], v[16:19], v[44:47], v[168:171]
    v_mfma_f32_16x16x32_bf16 v[172:175], v[20:23], v[44:47], v[172:175]
    s_waitcnt lgkmcnt(4)
    v_mfma_f32_16x16x32_bf16 v[152:155], v[24:27], v[48:51], v[152:155]
    v_mfma_f32_16x16x32_bf16 v[156:159], v[28:31], v[48:51], v[156:159]
    s_waitcnt lgkmcnt(2)
    v_mfma_f32_16x16x32_bf16 v[160:163], v[24:27], v[52:55], v[160:163]
    v_mfma_f32_16x16x32_bf16 v[164:167], v[28:31], v[52:55], v[164:167]
    s_waitcnt lgkmcnt(0)
    v_mfma_f32_16x16x32_bf16 v[168:171], v[24:27], v[56:59], v[168:171]
    v_mfma_f32_16x16x32_bf16 v[172:175], v[28:31], v[56:59], v[172:175]
    v_cvt_pk_bf16_f32 v152, v152, v153
    v_cvt_pk_bf16_f32 v153, v154, v155
    v_cvt_pk_bf16_f32 v154, v156, v157
    v_cvt_pk_bf16_f32 v155, v158, v159
    s_add_u32 s3, s27, 688160
    s_add_u32 s3, s3, s25
    v_permlane16_swap_b32 v152, v154
    v_permlane16_swap_b32 v153, v155
    buffer_store_dwordx4 v[152:155], v8, s[12:15], s3 offen sc1
    s_nop 7
    v_cvt_pk_bf16_f32 v160, v160, v161
    v_cvt_pk_bf16_f32 v161, v162, v163
    v_cvt_pk_bf16_f32 v162, v164, v165
    v_cvt_pk_bf16_f32 v163, v166, v167
    s_add_u32 s3, s26, s25
    s_nop 0
    v_permlane16_swap_b32 v160, v162
    v_permlane16_swap_b32 v161, v163
    buffer_store_dwordx4 v[160:163], v9, s[12:15], s3 offen
    v_cvt_pk_bf16_f32 v168, v168, v169
    v_cvt_pk_bf16_f32 v169, v170, v171
    v_cvt_pk_bf16_f32 v170, v172, v173
    v_cvt_pk_bf16_f32 v171, v174, v175
    s_add_u32 s3, s27, s25
    s_nop 0
    v_permlane16_swap_b32 v168, v170
    v_permlane16_swap_b32 v169, v171
    buffer_store_dwordx4 v[168:171], v176, s[12:15], s3 offen
    s_branch K1_FIN
K1_LOAD:
    s_sub_u32 s20, s19, 4
    v_lshrrev_b32 v3, 3, v2
    v_and_b32 v4, 7, v2
    v_xor_b32 v4, v4, v3
    v_lshlrev_b32 v4, 4, v4
    s_lshl_b32 s3, s20, 5
    v_add_u32 v5, s3, v3
    v_mul_u32_u24 v8, 1152, v5
    v_add_u32 v8, v8, v4
    s_mul_i32 s40, s17, 147456
    s_lshl_b32 s41, s20, 12
    s_lshr_b32 s37, s2, 3
    s_and_b32 s37, s37, 7
    s_lshr_b32 s3, s2, 6
    s_lshl_b32 s3, s3, 1
    s_add_u32 s37, s37, s3
    s_cmp_ge_u32 s37, 7
    s_cselect_b32 s3, 7, 0
    s_sub_u32 s37, s37, s3
    s_add_u32 s37, s37, 2
    s_mov_b32 s34, 0
    s_lshl_b32 s35, s34, 7
    s_add_u32 s35, s35, s40
    s_add_u32 m0, s41, 0
    s_mul_i32 s36, s34, 221184
    buffer_load_dwordx4 v8, s[4:7], s35 offen lds
    v_lshrrev_b32 v3, 5, v2
    v_mul_u32_u24 v3, 13824, v3
    v_and_b32 v4, 31, v2
    v_lshl_add_u32 v3, v4, 4, v3
    v_add_u32 v9, s45, v3
    s_mul_i32 s42, s20, 8448
    s_add_u32 s42, s42, 16384
    s_mul_i32 s44, s20, 55296
    s_add_u32 s36, s36, s44
    s_add_u32 m0, s41, 1024
    s_add_u32 s43, s35, 9216
    buffer_load_dwordx4 v8, s[4:7], s43 offen lds
    s_add_u32 m0, s41, 2048
    s_add_u32 s43, s35, 18432
    buffer_load_dwordx4 v8, s[4:7], s43 offen lds
    s_add_u32 m0, s41, 3072
    s_add_u32 s43, s35, 27648
    buffer_load_dwordx4 v8, s[4:7], s43 offen lds
    s_add_u32 m0, s42, 0
    s_add_u32 s43, s36, 0
    buffer_load_dwordx4 v9, s[8:11], s43 offen lds
    s_add_u32 m0, s42, 1056
    s_add_u32 s43, s36, 3456
    buffer_load_dwordx4 v9, s[8:11], s43 offen lds
    s_add_u32 m0, s42, 2112
    s_add_u32 s43, s36, 6912
    buffer_load_dwordx4 v9, s[8:11], s43 offen lds
    s_add_u32 m0, s42, 3168
    s_add_u32 s43, s36, 10368
    buffer_load_dwordx4 v9, s[8:11], s43 offen lds
    s_add_u32 m0, s42, 4224
    s_add_u32 s43, s36, 27648
    buffer_load_dwordx4 v9, s[8:11], s43 offen lds
    s_add_u32 m0, s42, 5280
    s_add_u32 s43, s36, 31104
    buffer_load_dwordx4 v9, s[8:11], s43 offen lds
    s_add_u32 m0, s42, 6336
    s_add_u32 s43, s36, 34560
    buffer_load_dwordx4 v9, s[8:11], s43 offen lds
    s_add_u32 m0, s42, 7392
    s_add_u32 s43, s36, 38016
    buffer_load_dwordx4 v9, s[8:11], s43 offen lds
    s_mov_b32 s34, 1
    s_lshl_b32 s35, s34, 7
    s_add_u32 s35, s35, s40
    s_mul_i32 s36, s34, 221184
    s_add_u32 s36, s36, s44
    s_add_u32 m0, s41, 50176
    s_add_u32 s43, s35, 0
    buffer_load_dwordx4 v8, s[4:7], s43 offen lds
    s_add_u32 m0, s41, 51200
    s_add_u32 s43, s35, 9216
    buffer_load_dwordx4 v8, s[4:7], s43 offen lds
    s_add_u32 m0, s41, 52224
    s_add_u32 s43, s35, 18432
    buffer_load_dwordx4 v8, s[4:7], s43 offen lds
    s_add_u32 m0, s41, 53248
    s_add_u32 s43, s35, 27648
    buffer_load_dwordx4 v8, s[4:7], s43 offen lds
    s_add_u32 m0, s42, 50176
    s_add_u32 s43, s36, 0
    buffer_load_dwordx4 v9, s[8:11], s43 offen lds
    s_add_u32 m0, s42, 51232
    s_add_u32 s43, s36, 3456
    buffer_load_dwordx4 v9, s[8:11], s43 offen lds
    s_add_u32 m0, s42, 52288
    s_add_u32 s43, s36, 6912
    buffer_load_dwordx4 v9, s[8:11], s43 offen lds
    s_add_u32 m0, s42, 53344
    s_add_u32 s43, s36, 10368
    buffer_load_dwordx4 v9, s[8:11], s43 offen lds
    s_add_u32 m0, s42, 54400
    s_add_u32 s43, s36, 27648
    buffer_load_dwordx4 v9, s[8:11], s43 offen lds
    s_add_u32 m0, s42, 55456
    s_add_u32 s43, s36, 31104
    buffer_load_dwordx4 v9, s[8:11], s43 offen lds
    s_add_u32 m0, s42, 56512
    s_add_u32 s43, s36, 34560
    buffer_load_dwordx4 v9, s[8:11], s43 offen lds
    s_add_u32 m0, s42, 57568
    s_add_u32 s43, s36, 38016
    buffer_load_dwordx4 v9, s[8:11], s43 offen lds
    s_mov_b32 s34, s37
    s_lshl_b32 s35, s34, 7
    s_add_u32 s35, s35, s40
    s_mul_i32 s36, s34, 221184
    s_add_u32 s36, s36, s44
    s_waitcnt vmcnt(12)
    s_barrier
    s_add_u32 m0, s41, 100352
    s_add_u32 s43, s35, 0
    buffer_load_dwordx4 v8, s[4:7], s43 offen lds
    s_add_u32 m0, s41, 101376
    s_add_u32 s43, s35, 9216
    buffer_load_dwordx4 v8, s[4:7], s43 offen lds
    s_add_u32 m0, s41, 102400
    s_add_u32 s43, s35, 18432
    buffer_load_dwordx4 v8, s[4:7], s43 offen lds
    s_add_u32 m0, s41, 103424
    s_add_u32 s43, s35, 27648
    buffer_load_dwordx4 v8, s[4:7], s43 offen lds
    s_add_u32 m0, s42, 100352
    s_add_u32 s43, s36, 0
    buffer_load_dwordx4 v9, s[8:11], s43 offen lds
    s_add_u32 m0, s42, 101408
    s_add_u32 s43, s36, 3456
    buffer_load_dwordx4 v9, s[8:11], s43 offen lds
    s_add_u32 m0, s42, 102464
    s_add_u32 s43, s36, 6912
    buffer_load_dwordx4 v9, s[8:11], s43 offen lds
    s_add_u32 m0, s42, 103520
    s_add_u32 s43, s36, 10368
    buffer_load_dwordx4 v9, s[8:11], s43 offen lds
    s_add_u32 m0, s42, 104576
    s_add_u32 s43, s36, 27648
    buffer_load_dwordx4 v9, s[8:11], s43 offen lds
    s_add_u32 m0, s42, 105632
    s_add_u32 s43, s36, 31104
    buffer_load_dwordx4 v9, s[8:11], s43 offen lds
    s_add_u32 m0, s42, 106688
    s_add_u32 s43, s36, 34560
    buffer_load_dwordx4 v9, s[8:11], s43 offen lds
    s_add_u32 m0, s42, 107744
    s_add_u32 s43, s36, 38016
    buffer_load_dwordx4 v9, s[8:11], s43 offen lds
    s_add_u32 s34, s34, 1
    s_cmp_eq_u32 s34, 9
    s_cselect_b32 s34, 2, s34
    s_lshl_b32 s35, s34, 7
    s_add_u32 s35, s35, s40
    s_mul_i32 s36, s34, 221184
    s_add_u32 s36, s36, s44
    s_waitcnt vmcnt(12)
    s_barrier
    s_add_u32 m0, s41, 0
    s_add_u32 s43, s35, 0
    buffer_load_dwordx4 v8, s[4:7], s43 offen lds
    s_add_u32 m0, s41, 1024
    s_add_u32 s43, s35, 9216
    buffer_load_dwordx4 v8, s[4:7], s43 offen lds
    s_add_u32 m0, s41, 2048
    s_add_u32 s43, s35, 18432
    buffer_load_dwordx4 v8, s[4:7], s43 offen lds
    s_add_u32 m0, s41, 3072
    s_add_u32 s43, s35, 27648
    buffer_load_dwordx4 v8, s[4:7], s43 offen lds
    s_add_u32 m0, s42, 0
    s_add_u32 s43, s36, 0
    buffer_load_dwordx4 v9, s[8:11], s43 offen lds
    s_add_u32 m0, s42, 1056
    s_add_u32 s43, s36, 3456
    buffer_load_dwordx4 v9, s[8:11], s43 offen lds
    s_add_u32 m0, s42, 2112
    s_add_u32 s43, s36, 6912
    buffer_load_dwordx4 v9, s[8:11], s43 offen lds
    s_add_u32 m0, s42, 3168
    s_add_u32 s43, s36, 10368
    buffer_load_dwordx4 v9, s[8:11], s43 offen lds
    s_add_u32 m0, s42, 4224
    s_add_u32 s43, s36, 27648
    buffer_load_dwordx4 v9, s[8:11], s43 offen lds
    s_add_u32 m0, s42, 5280
    s_add_u32 s43, s36, 31104
    buffer_load_dwordx4 v9, s[8:11], s43 offen lds
    s_add_u32 m0, s42, 6336
    s_add_u32 s43, s36, 34560
    buffer_load_dwordx4 v9, s[8:11], s43 offen lds
    s_add_u32 m0, s42, 7392
    s_add_u32 s43, s36, 38016
    buffer_load_dwordx4 v9, s[8:11], s43 offen lds
    s_add_u32 s34, s34, 1
    s_cmp_eq_u32 s34, 9
    s_cselect_b32 s34, 2, s34
    s_lshl_b32 s35, s34, 7
    s_add_u32 s35, s35, s40
    s_mul_i32 s36, s34, 221184
    s_add_u32 s36, s36, s44
    s_waitcnt vmcnt(12)
    s_barrier
    s_add_u32 m0, s41, 50176
    s_add_u32 s43, s35, 0
    buffer_load_dwordx4 v8, s[4:7], s43 offen lds
    s_add_u32 m0, s41, 51200
    s_add_u32 s43, s35, 9216
    buffer_load_dwordx4 v8, s[4:7], s43 offen lds
    s_add_u32 m0, s41, 52224
    s_add_u32 s43, s35, 18432
    buffer_load_dwordx4 v8, s[4:7], s43 offen lds
    s_add_u32 m0, s41, 53248
    s_add_u32 s43, s35, 27648
    buffer_load_dwordx4 v8, s[4:7], s43 offen lds
    s_add_u32 m0, s42, 50176
    s_add_u32 s43, s36, 0
    buffer_load_dwordx4 v9, s[8:11], s43 offen lds
    s_add_u32 m0, s42, 51232
    s_add_u32 s43, s36, 3456
    buffer_load_dwordx4 v9, s[8:11], s43 offen lds
    s_add_u32 m0, s42, 52288
    s_add_u32 s43, s36, 6912
    buffer_load_dwordx4 v9, s[8:11], s43 offen lds
    s_add_u32 m0, s42, 53344
    s_add_u32 s43, s36, 10368
    buffer_load_dwordx4 v9, s[8:11], s43 offen lds
    s_add_u32 m0, s42, 54400
    s_add_u32 s43, s36, 27648
    buffer_load_dwordx4 v9, s[8:11], s43 offen lds
    s_add_u32 m0, s42, 55456
    s_add_u32 s43, s36, 31104
    buffer_load_dwordx4 v9, s[8:11], s43 offen lds
    s_add_u32 m0, s42, 56512
    s_add_u32 s43, s36, 34560
    buffer_load_dwordx4 v9, s[8:11], s43 offen lds
    s_add_u32 m0, s42, 57568
    s_add_u32 s43, s36, 38016
    buffer_load_dwordx4 v9, s[8:11], s43 offen lds
    s_add_u32 s34, s34, 1
    s_cmp_eq_u32 s34, 9
    s_cselect_b32 s34, 2, s34
    s_lshl_b32 s35, s34, 7
    s_add_u32 s35, s35, s40
    s_mul_i32 s36, s34, 221184
    s_add_u32 s36, s36, s44
    s_waitcnt vmcnt(12)
    s_barrier
    s_add_u32 m0, s41, 100352
    s_add_u32 s43, s35, 0
    buffer_load_dwordx4 v8, s[4:7], s43 offen lds
    s_add_u32 m0, s41, 101376
    s_add_u32 s43, s35, 9216
    buffer_load_dwordx4 v8, s[4:7], s43 offen lds
    s_add_u32 m0, s41, 102400
    s_add_u32 s43, s35, 18432
    buffer_load_dwordx4 v8, s[4:7], s43 offen lds
    s_add_u32 m0, s41, 103424
    s_add_u32 s43, s35, 27648
    buffer_load_dwordx4 v8, s[4:7], s43 offen lds
    s_add_u32 m0, s42, 100352
    s_add_u32 s43, s36, 0
    buffer_load_dwordx4 v9, s[8:11], s43 offen lds
    s_add_u32 m0, s42, 101408
    s_add_u32 s43, s36, 3456
    buffer_load_dwordx4 v9, s[8:11], s43 offen lds
    s_add_u32 m0, s42, 102464
    s_add_u32 s43, s36, 6912
    buffer_load_dwordx4 v9, s[8:11], s43 offen lds
    s_add_u32 m0, s42, 103520
    s_add_u32 s43, s36, 10368
    buffer_load_dwordx4 v9, s[8:11], s43 offen lds
    s_add_u32 m0, s42, 104576
    s_add_u32 s43, s36, 27648
    buffer_load_dwordx4 v9, s[8:11], s43 offen lds
    s_add_u32 m0, s42, 105632
    s_add_u32 s43, s36, 31104
    buffer_load_dwordx4 v9, s[8:11], s43 offen lds
    s_add_u32 m0, s42, 106688
    s_add_u32 s43, s36, 34560
    buffer_load_dwordx4 v9, s[8:11], s43 offen lds
    s_add_u32 m0, s42, 107744
    s_add_u32 s43, s36, 38016
    buffer_load_dwordx4 v9, s[8:11], s43 offen lds
    s_add_u32 s34, s34, 1
    s_cmp_eq_u32 s34, 9
    s_cselect_b32 s34, 2, s34
    s_lshl_b32 s35, s34, 7
    s_add_u32 s35, s35, s40
    s_mul_i32 s36, s34, 221184
    s_add_u32 s36, s36, s44
    s_waitcnt vmcnt(12)
    s_barrier
    s_add_u32 m0, s41, 0
    s_add_u32 s43, s35, 0
    buffer_load_dwordx4 v8, s[4:7], s43 offen lds
    s_add_u32 m0, s41, 1024
    s_add_u32 s43, s35, 9216
    buffer_load_dwordx4 v8, s[4:7], s43 offen lds
    s_add_u32 m0, s41, 2048
    s_add_u32 s43, s35, 18432
    buffer_load_dwordx4 v8, s[4:7], s43 offen lds
    s_add_u32 m0, s41, 3072
    s_add_u32 s43, s35, 27648
    buffer_load_dwordx4 v8, s[4:7], s43 offen lds
    s_add_u32 m0, s42, 0
    s_add_u32 s43, s36, 0
    buffer_load_dwordx4 v9, s[8:11], s43 offen lds
    s_add_u32 m0, s42, 1056
    s_add_u32 s43, s36, 3456
    buffer_load_dwordx4 v9, s[8:11], s43 offen lds
    s_add_u32 m0, s42, 2112
    s_add_u32 s43, s36, 6912
    buffer_load_dwordx4 v9, s[8:11], s43 offen lds
    s_add_u32 m0, s42, 3168
    s_add_u32 s43, s36, 10368
    buffer_load_dwordx4 v9, s[8:11], s43 offen lds
    s_add_u32 m0, s42, 4224
    s_add_u32 s43, s36, 27648
    buffer_load_dwordx4 v9, s[8:11], s43 offen lds
    s_add_u32 m0, s42, 5280
    s_add_u32 s43, s36, 31104
    buffer_load_dwordx4 v9, s[8:11], s43 offen lds
    s_add_u32 m0, s42, 6336
    s_add_u32 s43, s36, 34560
    buffer_load_dwordx4 v9, s[8:11], s43 offen lds
    s_add_u32 m0, s42, 7392
    s_add_u32 s43, s36, 38016
    buffer_load_dwordx4 v9, s[8:11], s43 offen lds
    s_add_u32 s34, s34, 1
    s_cmp_eq_u32 s34, 9
    s_cselect_b32 s34, 2, s34
    s_lshl_b32 s35, s34, 7
    s_add_u32 s35, s35, s40
    s_mul_i32 s36, s34, 221184
    s_add_u32 s36, s36, s44
    s_waitcnt vmcnt(12)
    s_barrier
    s_add_u32 m0, s41, 50176
    s_add_u32 s43, s35, 0
    buffer_load_dwordx4 v8, s[4:7], s43 offen lds
    s_add_u32 m0, s41, 51200
    s_add_u32 s43, s35, 9216
    buffer_load_dwordx4 v8, s[4:7], s43 offen lds
    s_add_u32 m0, s41, 52224
    s_add_u32 s43, s35, 18432
    buffer_load_dwordx4 v8, s[4:7], s43 offen lds
    s_add_u32 m0, s41, 53248
    s_add_u32 s43, s35, 27648
    buffer_load_dwordx4 v8, s[4:7], s43 offen lds
    s_add_u32 m0, s42, 50176
    s_add_u32 s43, s36, 0
    buffer_load_dwordx4 v9, s[8:11], s43 offen lds
    s_add_u32 m0, s42, 51232
    s_add_u32 s43, s36, 3456
    buffer_load_dwordx4 v9, s[8:11], s43 offen lds
    s_add_u32 m0, s42, 52288
    s_add_u32 s43, s36, 6912
    buffer_load_dwordx4 v9, s[8:11], s43 offen lds
    s_add_u32 m0, s42, 53344
    s_add_u32 s43, s36, 10368
    buffer_load_dwordx4 v9, s[8:11], s43 offen lds
    s_add_u32 m0, s42, 54400
    s_add_u32 s43, s36, 27648
    buffer_load_dwordx4 v9, s[8:11], s43 offen lds
    s_add_u32 m0, s42, 55456
    s_add_u32 s43, s36, 31104
    buffer_load_dwordx4 v9, s[8:11], s43 offen lds
    s_add_u32 m0, s42, 56512
    s_add_u32 s43, s36, 34560
    buffer_load_dwordx4 v9, s[8:11], s43 offen lds
    s_add_u32 m0, s42, 57568
    s_add_u32 s43, s36, 38016
    buffer_load_dwordx4 v9, s[8:11], s43 offen lds
    s_add_u32 s34, s34, 1
    s_cmp_eq_u32 s34, 9
    s_cselect_b32 s34, 2, s34
    s_lshl_b32 s35, s34, 7
    s_add_u32 s35, s35, s40
    s_mul_i32 s36, s34, 221184
    s_add_u32 s36, s36, s44
    s_waitcnt vmcnt(12)
    s_barrier
    s_add_u32 m0, s41, 100352
    s_add_u32 s43, s35, 0
    buffer_load_dwordx4 v8, s[4:7], s43 offen lds
    s_add_u32 m0, s41, 101376
    s_add_u32 s43, s35, 9216
    buffer_load_dwordx4 v8, s[4:7], s43 offen lds
    s_add_u32 m0, s41, 102400
    s_add_u32 s43, s35, 18432
    buffer_load_dwordx4 v8, s[4:7], s43 offen lds
    s_add_u32 m0, s41, 103424
    s_add_u32 s43, s35, 27648
    buffer_load_dwordx4 v8, s[4:7], s43 offen lds
    s_add_u32 m0, s42, 100352
    s_add_u32 s43, s36, 0
    buffer_load_dwordx4 v9, s[8:11], s43 offen lds
    s_add_u32 m0, s42, 101408
    s_add_u32 s43, s36, 3456
    buffer_load_dwordx4 v9, s[8:11], s43 offen lds
    s_add_u32 m0, s42, 102464
    s_add_u32 s43, s36, 6912
    buffer_load_dwordx4 v9, s[8:11], s43 offen lds
    s_add_u32 m0, s42, 103520
    s_add_u32 s43, s36, 10368
    buffer_load_dwordx4 v9, s[8:11], s43 offen lds
    s_add_u32 m0, s42, 104576
    s_add_u32 s43, s36, 27648
    buffer_load_dwordx4 v9, s[8:11], s43 offen lds
    s_add_u32 m0, s42, 105632
    s_add_u32 s43, s36, 31104
    buffer_load_dwordx4 v9, s[8:11], s43 offen lds
    s_add_u32 m0, s42, 106688
    s_add_u32 s43, s36, 34560
    buffer_load_dwordx4 v9, s[8:11], s43 offen lds
    s_add_u32 m0, s42, 107744
    s_add_u32 s43, s36, 38016
    buffer_load_dwordx4 v9, s[8:11], s43 offen lds
    s_waitcnt vmcnt(12)
    s_barrier
    s_waitcnt vmcnt(0)
    s_barrier
K1_FIN:
K1_END:
    s_endpgm
.globl attn_kernel
.p2align 8
.type attn_kernel,@function
attn_kernel:
    s_cmp_ge_u32 s2, 256
    s_cbranch_scc1 K2_END
    s_setprio 3
    s_load_dwordx2 s[32:33], s[0:1], 64
    s_load_dwordx2 s[36:37], s[0:1], 16
    s_load_dwordx2 s[38:39], s[0:1], 40
    v_lshrrev_b32 v7, 6, v0
    v_and_b32 v1, 63, v0
    s_and_b32 s3, s2, 7
    v_readfirstlane_b32 s19, v7
    s_lshl_b32 s3, s3, 2
    s_lshr_b32 s16, s2, 3
    s_and_b32 s16, s16, 3
    s_add_u32 s16, s16, s3
    s_lshr_b32 s17, s2, 5
    v_lshlrev_b32 v2, 4, v1
    s_mul_i32 s3, s16, 229376
    s_add_u32 s23, s17, 7
    s_and_b32 s23, s23, 7
    s_lshl_b32 s20, s19, 10
    s_waitcnt lgkmcnt(0)
    s_add_u32 s34, s32, s3
    s_addc_u32 s35, s33, 0
    s_add_u32 s8, s34, 7340032
    s_addc_u32 s9, s35, 0
    s_mov_b32 s10, 229376
    s_mov_b32 s11, 0x00020000
    s_lshl_b32 s26, s17, 13
    s_add_u32 s26, s26, s20
    s_add_u32 m0, s20, 57344
    s_add_u32 s3, s26, 73728
    buffer_load_dwordx4 v2, s[8:11], s3 offen lds
    s_mul_i32 s26, s17, 9216
    s_add_u32 s27, s26, s20
    s_add_u32 m0, s20, 130048
    s_add_u32 s3, s27, 155648
    buffer_load_dwordx4 v2, s[8:11], s3 offen lds
    s_cmp_eq_u32 s19, 1
    s_cbranch_scc0 K2_BV7
    s_mov_b32 m0, 138240
    s_add_u32 s3, s26, 163840
    buffer_load_dwordx4 v2, s[8:11], s3 offen lds
K2_BV7:
    s_lshl_b32 s26, s23, 13
    s_add_u32 s26, s26, s20
    s_add_u32 m0, s20, 49152
    s_add_u32 s3, s26, 73728
    buffer_load_dwordx4 v2, s[8:11], s3 offen lds
    s_mul_i32 s26, s23, 9216
    s_add_u32 s27, s26, s20
    s_add_u32 m0, s20, 120832
    s_add_u32 s3, s27, 155648
    buffer_load_dwordx4 v2, s[8:11], s3 offen lds
    s_cmp_eq_u32 s19, 0
    s_cbranch_scc0 K2_BV6
    s_mov_b32 m0, 129024
    s_add_u32 s3, s26, 163840
    buffer_load_dwordx4 v2, s[8:11], s3 offen lds
K2_BV6:
    s_lshr_b32 s21, s19, 2
    s_and_b32 s22, s19, 3
    s_lshl_b32 s22, s22, 1
    s_add_u32 s22, s22, s21
    s_lshl_b32 s18, s17, 3
    s_add_u32 s18, s18, s22
    v_and_b32 v7, 31, v1
    v_and_b32 v8, 32, v1
    v_lshlrev_b32 v8, 26, v8
    v_lshl_or_b32 v8, v7, 2, v8
    s_lshl_b32 s24, s18, 10
    s_lshl_b32 s25, s18, 7
    s_add_u32 s25, s25, 65536
    buffer_load_dwordx4 v[24:27], v2, s[8:11], s24 offen
    buffer_load_dword v32, v8, s[8:11], s25 offen
    s_cmp_lt_u32 s19, 4
    s_cbranch_scc1 K2_BK2D
    s_and_b32 s28, s19, 1
    s_lshl_b32 s28, s28, 10
    s_cmp_lt_u32 s19, 6
    s_cselect_b32 s29, s23, s17
    s_cselect_b32 s26, 0, 2048
    s_add_u32 s26, s26, 151552
    s_add_u32 s26, s26, s28
    s_lshl_b32 s29, s29, 11
    s_add_u32 s29, s29, s28
    s_add_u32 s29, s29, 139264
    s_cmp_lt_u32 s19, 6
    s_cselect_b32 s27, 1, 0
    s_cmp_eq_u32 s17, 0
    s_cselect_b32 s27, s27, 0
    s_cmp_eq_u32 s27, 1
    s_cbranch_scc1 K2_BK2F
    s_mov_b32 m0, s26
    s_nop 0
    buffer_load_dwordx4 v2, s[8:11], s29 offen lds
    s_branch K2_BK2D
K2_BK2F:
    v_add_u32 v10, s26, v2
    v_mov_b32 v12, 0
    v_mov_b32 v13, 0x3F803F80
    v_mov_b32 v14, 0
    v_mov_b32 v15, 0x3F803F80
    ds_write_b128 v10, v[12:15]
K2_BK2D:
    s_mov_b32 s4, s34
    s_mov_b32 s5, s35
    s_mov_b32 s6, 229376
    s_mov_b32 s7, 0x00020000
    s_setprio 0
    s_add_u32 s34, s32, 14680064
    s_addc_u32 s35, s33, 0
    s_mov_b32 s12, s34
    s_mov_b32 s13, s35
    s_mov_b32 s14, 4718592
    s_mov_b32 s15, 0x00020000
    s_mov_b32 s40, 0x0003FFFF
    s_mov_b32 s41, 0x0003FFFF
    s_mov_b32 s42, -1
    s_mov_b32 s43, 0
    v_lshrrev_b32 v9, 5, v1
    v_mov_b32 v6, 0xDDDDDDDD
    v_mov_b32 v208, 0
    v_mov_b32 v209, 0
    v_mov_b32 v29, 0
    v_mov_b32 v31, 0
    v_mov_b32 v33, 0
    s_lshr_b32 s24, s19, 1
    s_and_b32 s25, s19, 1
    s_lshl_b32 s26, s24, 3
    s_lshl_b32 s27, s25, 1
    s_add_u32 s26, s26, s27
    v_lshlrev_b32 v10, 2, v9
    v_sub_u32 v10, v7, v10
    v_mov_b32 v11, 0xf1800000
    v_cmp_le_i32 vcc, s26, v10
    v_cmp_lt_i32 s[44:45], s26, v10
    s_lshl_b32 s24, s24, 10
    s_lshl_b32 s25, s25, 3
    s_add_u32 s24, s24, s25
    s_add_u32 s24, s24, 155648
    v_cndmask_b32 v12, v11, v208, vcc
    v_cndmask_b32 v13, v11, v208, s[44:45]
    v_cndmask_b32 v14, v208, v11, vcc
    v_cndmask_b32 v15, v208, v11, s[44:45]
    v_add_u32 v10, s24, v2
    ds_write_b64 v10, v[12:13]
    ds_write_b64 v10, v[14:15] offset:4096
    v_mov_b32 v11, 0x3F803F80
    v_cmp_eq_u32 vcc, 18, v7
    v_lshlrev_b32 v206, 3, v7
    v_add_u32 v46, 139264, v206
    v_cndmask_b32 v10, v208, v11, vcc
    v_mfma_f32_32x32x8bf16_1k v[128:143], v[208:209], v[208:209], 0
    v_mov_b32 v48, v10
    v_mov_b32 v49, v10
    v_mov_b32 v50, v10
    v_mov_b32 v51, v10
    v_mov_b32 v52, v10
    v_mov_b32 v53, v10
    v_mov_b32 v54, v10
    v_mov_b32 v55, v10
    v_mov_b32 v56, v10
    v_mov_b32 v57, v10
    v_mov_b32 v58, v10
    v_mov_b32 v59, v10
    v_mov_b32 v60, v10
    v_mov_b32 v61, v10
    v_mov_b32 v62, v10
    v_mov_b32 v63, v10
    v_mul_u32_u24 v207, 288, v9
    v_lshl_add_u32 v207, v7, 4, v207
    v_add_u32 v47, 65536, v207
    s_add_u32 s24, s22, 48
    s_lshl_b32 s25, s24, 10
    v_add_u32 v3, s25, v2
    s_lshl_b32 s25, s24, 8
    v_add_u32 v4, s25, v46
    s_mul_i32 s25, s24, 1152
    v_add_u32 v5, s25, v47
    s_lshl_b32 s24, s18, 5
    v_add_u32 v13, s24, v7
    s_lshl_b32 s24, s16, 16
    v_lshlrev_b32 v197, 5, v13
    v_lshl_add_u32 v197, v9, 4, v197
    v_add_u32 v197, s24, v197
    s_lshl_b32 s24, s16, 13
    s_add_u32 s24, s24, 2097152
    v_lshlrev_b32 v198, 2, v13
    v_add_u32 v198, s24, v198
    s_mov_b32 s54, 2359296
    s_cmp_eq_u32 s18, 0
    s_cselect_b32 s24, 8, 7
    s_lshl_b32 s25, s24, 10
    v_add_u32 v13, s25, v3
    s_lshl_b32 s25, s24, 8
    v_add_u32 v14, s25, v4
    v_add_u32 v12, 155648, v2
    s_waitcnt vmcnt(0) lgkmcnt(0)
    s_barrier
    ds_read_b128 v[200:203], v13
    ds_read_b64 v[204:205], v14
    ds_read_b128 v[34:37], v3 offset:0
    ds_read_b64 v[42:43], v4 offset:0
    ds_read_b128 v[38:41], v3 offset:1024
    ds_read_b64 v[44:45], v4 offset:256
    s_mov_b64 exec, s[40:41]
    ds_read_b128 v[48:51], v5 offset:0
    ds_read_b128 v[52:55], v5 offset:576
    s_mov_b64 exec, -1
    ds_read_b128 v[160:163], v12 offset:4096
    ds_read_b128 v[164:167], v12 offset:5120
    ds_read_b128 v[168:171], v12 offset:6144
    ds_read_b128 v[172:175], v12 offset:7168
    s_sub_u32 s26, s18, s21
    s_lshl_b32 s24, s26, 10
    s_lshl_b32 s25, s26, 7
    s_add_u32 s25, s25, 65536
    buffer_load_dwordx4 v[16:19], v2, s[4:7], s24 offen
    buffer_load_dwordx4 v[20:23], v2, s[4:7], s24 offen offset:1024
    buffer_load_dword v28, v8, s[4:7], s25 offen
    buffer_load_dword v30, v8, s[4:7], s25 offen offset:128
    s_waitcnt lgkmcnt(10)
    s_cmp_eq_u32 s18, 0
    s_cbranch_scc1 K2_SMPM
    v_mfma_f32_32x32x16_bf16 v[64:79], v[200:203], v[24:27], 0
    ds_read_b128 v[176:179], v12 offset:0
    ds_read_b128 v[180:183], v12 offset:1024
    ds_read_b128 v[184:187], v12 offset:2048
    ds_read_b128 v[188:191], v12 offset:3072
    s_branch K2_SMPJ
K2_SMPM:
    ds_read_b128 v[176:179], v12 offset:0
    ds_read_b128 v[180:183], v12 offset:1024
    ds_read_b128 v[184:187], v12 offset:2048
    ds_read_b128 v[188:191], v12 offset:3072
    s_waitcnt lgkmcnt(0)
    v_mfma_f32_32x32x16_bf16 v[64:79], v[200:203], v[24:27], v[176:191]
K2_SMPJ:
    v_mfma_f32_32x32x8bf16_1k v[64:79], v[204:205], v[32:33], v[64:79]
    s_add_u32 m0, s20, 0
    s_add_u32 s3, s20, 73728
    buffer_load_dwordx4 v2, s[4:7], s3 offen lds
    s_nop 7
    s_nop 3
    v_max3_f32 v10, v64, v65, v66
    v_max3_f32 v10, v67, v68, v10
    v_max3_f32 v10, v69, v70, v10
    v_max3_f32 v10, v71, v72, v10
    v_max3_f32 v10, v73, v74, v10
    v_max3_f32 v10, v75, v76, v10
    v_max3_f32 v10, v77, v78, v10
    v_max_f32 v10, v79, v10
    v_mov_b32 v11, v10
    s_nop 1
    v_permlane32_swap_b32 v10, v11
    s_nop 1
    v_max_f32 v10, v10, v11
    v_sub_f32 v10, 0xc2b40000, v10
    v_lshrrev_b32 v10, 16, v10
    s_mov_b64 exec, s[42:43]
    v_or_b32 v33, 0xf1800000, v10
    s_mov_b64 exec, -1
    s_waitcnt lgkmcnt(0)
    s_nop 0
    v_mfma_f32_32x32x16_bf16 v[64:79], v[34:37], v[24:27], v[160:175]
    v_mfma_f32_32x32x8bf16_1k v[64:79], v[42:43], v[32:33], v[64:79]
    s_nop 7
    s_nop 7
    v_exp_f32 v64, v64
    v_exp_f32 v65, v65
    v_exp_f32 v66, v66
    v_exp_f32 v67, v67
    s_add_u32 m0, s20, 65536
    s_add_u32 s3, s20, 155648
    buffer_load_dwordx4 v2, s[4:7], s3 offen lds
    v_exp_f32 v68, v68
    v_exp_f32 v69, v69
    s_waitcnt lgkmcnt(0)
    v_mfma_f32_32x32x16_bf16 v[80:95], v[38:41], v[24:27], 0
    v_exp_f32 v70, v70
    v_exp_f32 v71, v71
    v_exp_f32 v72, v72
    v_exp_f32 v73, v73
    v_mfma_f32_32x32x8bf16_1k v[80:95], v[44:45], v[32:33], v[80:95]
    ds_read_b128 v[34:37], v3 offset:2048
    ds_read_b64 v[42:43], v4 offset:512
    s_mov_b64 exec, s[40:41]
    ds_read_b128 v[56:59], v5 offset:1152
    ds_read_b128 v[60:63], v5 offset:1728
    s_mov_b64 exec, -1
    v_exp_f32 v74, v74
    v_exp_f32 v75, v75
    v_exp_f32 v76, v76
    v_exp_f32 v77, v77
    v_smfmac_f32_32x32x32_bf16 v[128:143], v[48:51], v[64:71], v6
    v_exp_f32 v78, v78
    v_exp_f32 v79, v79
    v_exp_f32 v80, v80
    v_exp_f32 v81, v81
    v_smfmac_f32_32x32x32_bf16 v[128:143], v[52:55], v[72:79], v6
    v_exp_f32 v82, v82
    v_exp_f32 v83, v83
    s_add_u32 m0, s20, 139264
    s_add_u32 s3, s20, 139264
    buffer_load_dwordx4 v2, s[4:7], s3 offen lds
    v_exp_f32 v84, v84
    v_exp_f32 v85, v85
    s_waitcnt lgkmcnt(0)
    v_mfma_f32_32x32x16_bf16 v[64:79], v[34:37], v[24:27], 0
    v_exp_f32 v86, v86
    v_exp_f32 v87, v87
    v_exp_f32 v88, v88
    v_exp_f32 v89, v89
    v_mfma_f32_32x32x8bf16_1k v[64:79], v[42:43], v[32:33], v[64:79]
    ds_read_b128 v[38:41], v3 offset:3072
    ds_read_b64 v[44:45], v4 offset:768
    s_mov_b64 exec, s[40:41]
    ds_read_b128 v[48:51], v5 offset:2304
    ds_read_b128 v[52:55], v5 offset:2880
    s_mov_b64 exec, -1
    v_exp_f32 v90, v90
    v_exp_f32 v91, v91
    v_exp_f32 v92, v92
    v_exp_f32 v93, v93
    v_smfmac_f32_32x32x32_bf16 v[128:143], v[56:59], v[80:87], v6
    v_exp_f32 v94, v94
    v_exp_f32 v95, v95
    v_exp_f32 v64, v64
    v_exp_f32 v65, v65
    v_smfmac_f32_32x32x32_bf16 v[128:143], v[60:63], v[88:95], v6
    v_exp_f32 v66, v66
    v_exp_f32 v67, v67
    s_add_u32 m0, s20, 8192
    s_add_u32 s3, s20, 81920
    buffer_load_dwordx4 v2, s[4:7], s3 offen lds
    v_exp_f32 v68, v68
    v_exp_f32 v69, v69
    s_waitcnt lgkmcnt(0)
    v_mfma_f32_32x32x16_bf16 v[80:95], v[38:41], v[24:27], 0
    v_exp_f32 v70, v70
    v_exp_f32 v71, v71
    v_exp_f32 v72, v72
    v_exp_f32 v73, v73
    v_mfma_f32_32x32x8bf16_1k v[80:95], v[44:45], v[32:33], v[80:95]
    ds_read_b128 v[34:37], v3 offset:4096
    ds_read_b64 v[42:43], v4 offset:1024
    s_mov_b64 exec, s[40:41]
    ds_read_b128 v[56:59], v5 offset:3456
    ds_read_b128 v[60:63], v5 offset:4032
    s_mov_b64 exec, -1
    v_exp_f32 v74, v74
    v_exp_f32 v75, v75
    v_exp_f32 v76, v76
    v_exp_f32 v77, v77
    v_smfmac_f32_32x32x32_bf16 v[128:143], v[48:51], v[64:71], v6
    v_exp_f32 v78, v78
    v_exp_f32 v79, v79
    v_exp_f32 v80, v80
    v_exp_f32 v81, v81
    v_smfmac_f32_32x32x32_bf16 v[128:143], v[52:55], v[72:79], v6
    v_exp_f32 v82, v82
    v_exp_f32 v83, v83
    s_add_u32 m0, s20, 73728
    s_add_u32 s3, s20, 163840
    buffer_load_dwordx4 v2, s[4:7], s3 offen lds
    v_exp_f32 v84, v84
    v_exp_f32 v85, v85
    s_waitcnt lgkmcnt(0)
    v_mfma_f32_32x32x16_bf16 v[64:79], v[34:37], v[24:27], 0
    v_exp_f32 v86, v86
    v_exp_f32 v87, v87
    v_exp_f32 v88, v88
    v_exp_f32 v89, v89
    v_mfma_f32_32x32x8bf16_1k v[64:79], v[42:43], v[32:33], v[64:79]
    ds_read_b128 v[38:41], v3 offset:5120
    ds_read_b64 v[44:45], v4 offset:1280
    s_mov_b64 exec, s[40:41]
    ds_read_b128 v[48:51], v5 offset:4608
    ds_read_b128 v[52:55], v5 offset:5184
    s_mov_b64 exec, -1
    v_exp_f32 v90, v90
    v_exp_f32 v91, v91
    v_exp_f32 v92, v92
    v_exp_f32 v93, v93
    v_smfmac_f32_32x32x32_bf16 v[128:143], v[56:59], v[80:87], v6
    v_exp_f32 v94, v94
    v_exp_f32 v95, v95
    v_exp_f32 v64, v64
    v_exp_f32 v65, v65
    v_smfmac_f32_32x32x32_bf16 v[128:143], v[60:63], v[88:95], v6
    v_exp_f32 v66, v66
    v_exp_f32 v67, v67
    s_add_u32 m0, s20, 81920
    s_add_u32 s3, s20, 172032
    buffer_load_dwordx4 v2, s[4:7], s3 offen lds
    v_exp_f32 v68, v68
    v_exp_f32 v69, v69
    s_waitcnt lgkmcnt(0)
    v_mfma_f32_32x32x16_bf16 v[80:95], v[38:41], v[24:27], 0
    v_exp_f32 v70, v70
    v_exp_f32 v71, v71
    v_exp_f32 v72, v72
    v_exp_f32 v73, v73
    v_mfma_f32_32x32x8bf16_1k v[80:95], v[44:45], v[32:33], v[80:95]
    ds_read_b128 v[34:37], v3 offset:6144
    ds_read_b64 v[42:43], v4 offset:1536
    s_mov_b64 exec, s[40:41]
    ds_read_b128 v[56:59], v5 offset:5760
    ds_read_b128 v[60:63], v5 offset:6336
    s_mov_b64 exec, -1
    v_exp_f32 v74, v74
    v_exp_f32 v75, v75
    v_exp_f32 v76, v76
    v_exp_f32 v77, v77
    v_smfmac_f32_32x32x32_bf16 v[128:143], v[48:51], v[64:71], v6
    v_exp_f32 v78, v78
    v_exp_f32 v79, v79
    v_exp_f32 v80, v80
    v_exp_f32 v81, v81
    v_smfmac_f32_32x32x32_bf16 v[128:143], v[52:55], v[72:79], v6
    v_exp_f32 v82, v82
    v_exp_f32 v83, v83
    s_add_u32 m0, s20, 16384
    s_add_u32 s3, s20, 90112
    buffer_load_dwordx4 v2, s[4:7], s3 offen lds
    v_exp_f32 v84, v84
    v_exp_f32 v85, v85
    s_waitcnt lgkmcnt(0)
    v_mfma_f32_32x32x16_bf16 v[64:79], v[34:37], v[24:27], 0
    v_exp_f32 v86, v86
    v_exp_f32 v87, v87
    v_exp_f32 v88, v88
    v_exp_f32 v89, v89
    v_mfma_f32_32x32x8bf16_1k v[64:79], v[42:43], v[32:33], v[64:79]
    ds_read_b128 v[38:41], v3 offset:7168
    ds_read_b64 v[44:45], v4 offset:1792
    s_mov_b64 exec, s[40:41]
    ds_read_b128 v[48:51], v5 offset:6912
    ds_read_b128 v[52:55], v5 offset:7488
    s_mov_b64 exec, -1
    v_exp_f32 v90, v90
    v_exp_f32 v91, v91
    v_exp_f32 v92, v92
    v_exp_f32 v93, v93
    v_smfmac_f32_32x32x32_bf16 v[128:143], v[56:59], v[80:87], v6
    v_exp_f32 v94, v94
    v_exp_f32 v95, v95
    v_exp_f32 v64, v64
    v_exp_f32 v65, v65
    v_smfmac_f32_32x32x32_bf16 v[128:143], v[60:63], v[88:95], v6
    v_exp_f32 v66, v66
    v_exp_f32 v67, v67
    s_add_u32 m0, s20, 90112
    s_add_u32 s3, s20, 180224
    buffer_load_dwordx4 v2, s[4:7], s3 offen lds
    v_exp_f32 v68, v68
    v_exp_f32 v69, v69
    s_waitcnt lgkmcnt(0)
    v_mfma_f32_32x32x16_bf16 v[80:95], v[38:41], v[24:27], 0
    v_exp_f32 v70, v70
    v_exp_f32 v71, v71
    v_exp_f32 v72, v72
    v_exp_f32 v73, v73
    v_mfma_f32_32x32x8bf16_1k v[80:95], v[44:45], v[32:33], v[80:95]
    ds_read_b128 v[34:37], v3 offset:8192
    ds_read_b64 v[42:43], v4 offset:2048
    s_mov_b64 exec, s[40:41]
    ds_read_b128 v[56:59], v5 offset:8064
    ds_read_b128 v[60:63], v5 offset:8640
    s_mov_b64 exec, -1
    v_exp_f32 v74, v74
    v_exp_f32 v75, v75
    v_exp_f32 v76, v76
    v_exp_f32 v77, v77
    v_smfmac_f32_32x32x32_bf16 v[128:143], v[48:51], v[64:71], v6
    v_exp_f32 v78, v78
    v_exp_f32 v79, v79
    v_exp_f32 v80, v80
    v_exp_f32 v81, v81
    v_smfmac_f32_32x32x32_bf16 v[128:143], v[52:55], v[72:79], v6
    v_exp_f32 v82, v82
    v_exp_f32 v83, v83
    s_add_u32 m0, s20, 24576
    s_add_u32 s3, s20, 98304
    buffer_load_dwordx4 v2, s[4:7], s3 offen lds
    v_exp_f32 v84, v84
    v_exp_f32 v85, v85
    s_waitcnt lgkmcnt(0)
    v_mfma_f32_32x32x16_bf16 v[64:79], v[34:37], v[24:27], v[176:191]
    v_exp_f32 v86, v86
    v_exp_f32 v87, v87
    v_exp_f32 v88, v88
    v_exp_f32 v89, v89
    v_mfma_f32_32x32x8bf16_1k v[64:79], v[42:43], v[32:33], v[64:79]
    s_nop 0
    s_nop 0
    s_mov_b64 exec, s[40:41]
    ds_read_b128 v[48:51], v5 offset:9216
    ds_read_b128 v[52:55], v5 offset:9792
    s_mov_b64 exec, -1
    v_exp_f32 v90, v90
    v_exp_f32 v91, v91
    v_exp_f32 v92, v92
    v_exp_f32 v93, v93
    v_smfmac_f32_32x32x32_bf16 v[128:143], v[56:59], v[80:87], v6
    v_exp_f32 v94, v94
    v_exp_f32 v95, v95
    v_exp_f32 v64, v64
    v_exp_f32 v65, v65
    v_smfmac_f32_32x32x32_bf16 v[128:143], v[60:63], v[88:95], v6
    v_exp_f32 v66, v66
    v_exp_f32 v67, v67
    s_add_u32 m0, s20, 98304
    s_add_u32 s3, s20, 188416
    buffer_load_dwordx4 v2, s[4:7], s3 offen lds
    v_exp_f32 v68, v68
    v_exp_f32 v69, v69
    s_waitcnt lgkmcnt(0)
    v_exp_f32 v70, v70
    v_exp_f32 v71, v71
    v_exp_f32 v72, v72
    v_exp_f32 v73, v73
    v_exp_f32 v74, v74
    v_exp_f32 v75, v75
    v_exp_f32 v76, v76
    v_exp_f32 v77, v77
    v_smfmac_f32_32x32x32_bf16 v[128:143], v[48:51], v[64:71], v6
    v_exp_f32 v78, v78
    v_exp_f32 v79, v79
    s_nop 1
    v_smfmac_f32_32x32x32_bf16 v[128:143], v[52:55], v[72:79], v6
    s_nop 7
    s_nop 7
    s_mov_b32 s56, s8
    s_mov_b32 s57, s9
    s_mov_b32 s58, 229376
    s_mov_b32 s59, 0x00020000
    s_mov_b32 s48, 0
    s_sub_u32 s51, s18, 8
    s_max_i32 s49, s51, 0
    s_mov_b32 s50, s18
    s_mov_b32 s52, s18
    v_mov_b32 v7, v138
    v_mov_b32 v8, v138
    v_mul_f32 v9, 0, v128
    s_nop 0
    v_permlane32_swap_b32 v7, v8
    v_fmac_f32 v9, 0, v129
    v_fmac_f32 v9, 0, v130
    v_fmac_f32 v9, 0, v131
    v_fmac_f32 v9, 0, v132
    v_fmac_f32 v9, 0, v133
    v_fmac_f32 v9, 0, v134
    v_fmac_f32 v9, 0, v135
    v_fmac_f32 v9, 0, v136
    v_fmac_f32 v9, 0, v137
    v_add_f32 v9, v7, v9
    s_mov_b32 s3, 0x0d800000
    v_cmp_le_f32 vcc, s3, v9
    s_mov_b32 s3, 0x79000000
    v_cmp_ge_f32 s[44:45], s3, v9
    v_rcp_f32 v7, v7
    s_nop 2
    s_and_b64 vcc, vcc, s[44:45]
    s_cmp_eq_u64 vcc, -1
    s_cbranch_scc0 K2_SLOWB
K2_DONEB:
    v_mul_f32 v128, v7, v128
    v_mul_f32 v129, v7, v129
    v_mul_f32 v130, v7, v130
    v_mul_f32 v131, v7, v131
    v_mul_f32 v132, v7, v132
    v_mul_f32 v133, v7, v133
    v_mul_f32 v134, v7, v134
    v_mul_f32 v135, v7, v135
    v_mul_f32 v136, v7, v136
    v_mul_f32 v137, v7, v137
    v_cvt_pk_bf16_f32 v192, v128, v129
    v_cvt_pk_bf16_f32 v193, v130, v131
    v_cvt_pk_bf16_f32 v194, v132, v133
    v_cvt_pk_bf16_f32 v195, v134, v135
    v_cvt_pk_bf16_f32 v196, v136, v137
    s_nop 0
    v_permlane32_swap_b32 v192, v194
    v_permlane32_swap_b32 v193, v195
    s_waitcnt vmcnt(0)
    buffer_store_dwordx4 v[192:195], v197, s[12:15], s54 offen sc1
    s_mov_b64 exec, s[42:43]
    buffer_store_dword v196, v198, s[12:15], s54 offen
    s_mov_b64 exec, -1
    s_barrier
    s_lshl_b32 s24, s21, 10
    v_add_u32 v3, s24, v2
    s_lshl_b32 s24, s21, 8
    v_add_u32 v4, s24, v46
    s_mul_i32 s24, s21, 1152
    v_add_u32 v5, s24, v47
    ds_read_b128 v[34:37], v3 offset:0
    ds_read_b64 v[42:43], v4 offset:0
    ds_read_b128 v[38:41], v3 offset:2048
    ds_read_b64 v[44:45], v4 offset:512
    s_mov_b64 exec, s[40:41]
    ds_read_b128 v[48:51], v5 offset:0
    ds_read_b128 v[52:55], v5 offset:576
    s_mov_b64 exec, -1
    v_mfma_f32_32x32x8bf16_1k v[80:95], v[208:209], v[208:209], 0
    v_mfma_f32_32x32x8bf16_1k v[112:127], v[208:209], v[208:209], 0
    v_mfma_f32_32x32x8bf16_1k v[128:143], v[208:209], v[208:209], 0
    v_mfma_f32_32x32x8bf16_1k v[144:159], v[208:209], v[208:209], 0
    s_waitcnt lgkmcnt(0)
    v_mfma_f32_32x32x16_bf16 v[64:79], v[34:37], v[16:19], 0
    v_mfma_f32_32x32x16_bf16 v[96:111], v[34:37], v[20:23], 0
    v_mfma_f32_32x32x8bf16_1k v[64:79], v[42:43], v[28:29], v[64:79]
    v_mfma_f32_32x32x8bf16_1k v[96:111], v[42:43], v[30:31], v[96:111]
    s_mov_b32 s47, 0
    s_nop 3
    s_add_u32 s53, s20, 32768
    s_add_u32 m0, s20, 147456
    s_add_u32 s3, s20, 147456
    buffer_load_dwordx4 v2, s[4:7], s3 offen lds
    s_mov_b32 m0, s53
    s_add_u32 s3, s53, 73728
    buffer_load_dwordx4 v2, s[4:7], s3 offen lds
    s_add_u32 m0, s53, 73728
    s_add_u32 s3, s53, 163840
    buffer_load_dwordx4 v2, s[4:7], s3 offen lds
    s_add_u32 s53, s53, 8192
    s_cmp_eq_u32 s19, 0
    s_cbranch_scc0 K2_NOWO
    s_cmp_lt_u32 s2, 128
    s_cselect_b32 s36, s36, s38
    s_cselect_b32 s37, s37, s39
    s_mov_b32 s38, 663552
    s_mov_b32 s39, 0x00020000
    s_and_b32 s3, s2, 127
    s_mul_i32 s3, s3, 5184
    v_lshlrev_b32 v7, 6, v1
    buffer_load_dword v210, v7, s[36:39], s3 offen
    buffer_load_dword v211, v7, s[36:39], s3 offen offset:4032
K2_NOWO:
K2_ALOOP:
    s_cmp_lt_u32 s47, 3
    s_cbranch_scc0 K2_NODMA
    s_mov_b32 m0, s53
    s_add_u32 s3, s53, 73728
    buffer_load_dwordx4 v2, s[4:7], s3 offen lds
    s_add_u32 m0, s53, 73728
    s_add_u32 s3, s53, 163840
    buffer_load_dwordx4 v2, s[4:7], s3 offen lds
    s_add_u32 s53, s53, 8192
    s_branch K2_NOBAR
K2_NODMA:
    s_cmp_eq_u32 s47, 3
    s_cbranch_scc0 K2_NOBAR
    s_waitcnt vmcnt(0)
    s_barrier
K2_NOBAR:
    s_setprio 1
    v_exp_f32 v64, v64
    v_exp_f32 v65, v65
    v_smfmac_f32_32x32x32_bf16 v[128:143], v[60:63], v[88:95], v6
    v_exp_f32 v66, v66
    v_exp_f32 v67, v67
    v_exp_f32 v68, v68
    s_waitcnt lgkmcnt(0)
    v_exp_f32 v69, v69
    v_mfma_f32_32x32x16_bf16 v[80:95], v[38:41], v[16:19], 0
    v_exp_f32 v70, v70
    v_exp_f32 v71, v71
    ds_read_b128 v[34:37], v3 offset:4096
    v_exp_f32 v72, v72
    v_exp_f32 v73, v73
    v_mfma_f32_32x32x8bf16_1k v[80:95], v[44:45], v[28:29], v[80:95]
    v_exp_f32 v74, v74
    ds_read_b64 v[42:43], v4 offset:1024
    v_exp_f32 v75, v75
    v_exp_f32 v76, v76
    v_exp_f32 v77, v77
    v_smfmac_f32_32x32x32_bf16 v[128:143], v[48:51], v[64:71], v6
    v_exp_f32 v78, v78
    v_exp_f32 v79, v79
    s_setprio 0
    v_exp_f32 v96, v96
    v_exp_f32 v97, v97
    v_smfmac_f32_32x32x32_bf16 v[144:159], v[60:63], v[120:127], v6
    v_exp_f32 v98, v98
    s_mov_b64 exec, s[40:41]
    ds_read_b128 v[56:59], v5 offset:2304
    ds_read_b128 v[60:63], v5 offset:2880
    s_mov_b64 exec, -1
    v_exp_f32 v99, v99
    v_exp_f32 v100, v100
    v_exp_f32 v101, v101
    v_mfma_f32_32x32x16_bf16 v[112:127], v[38:41], v[20:23], 0
    v_exp_f32 v102, v102
    v_exp_f32 v103, v103
    v_exp_f32 v104, v104
    v_exp_f32 v105, v105
    v_mfma_f32_32x32x8bf16_1k v[112:127], v[44:45], v[30:31], v[112:127]
    v_exp_f32 v106, v106
    v_exp_f32 v107, v107
    v_exp_f32 v108, v108
    v_exp_f32 v109, v109
    v_smfmac_f32_32x32x32_bf16 v[144:159], v[48:51], v[96:103], v6
    v_exp_f32 v110, v110
    v_exp_f32 v111, v111
    s_setprio 1
    v_exp_f32 v80, v80
    v_exp_f32 v81, v81
    v_smfmac_f32_32x32x32_bf16 v[128:143], v[52:55], v[72:79], v6
    v_exp_f32 v82, v82
    v_exp_f32 v83, v83
    v_exp_f32 v84, v84
    s_waitcnt lgkmcnt(0)
    v_exp_f32 v85, v85
    v_mfma_f32_32x32x16_bf16 v[64:79], v[34:37], v[16:19], 0
    v_exp_f32 v86, v86
    v_exp_f32 v87, v87
    ds_read_b128 v[38:41], v3 offset:6144
    v_exp_f32 v88, v88
    v_exp_f32 v89, v89
    v_mfma_f32_32x32x8bf16_1k v[64:79], v[42:43], v[28:29], v[64:79]
    v_exp_f32 v90, v90
    ds_read_b64 v[44:45], v4 offset:1536
    v_exp_f32 v91, v91
    v_exp_f32 v92, v92
    v_exp_f32 v93, v93
    v_smfmac_f32_32x32x32_bf16 v[128:143], v[56:59], v[80:87], v6
    v_exp_f32 v94, v94
    v_exp_f32 v95, v95
    s_setprio 0
    v_exp_f32 v112, v112
    v_exp_f32 v113, v113
    v_smfmac_f32_32x32x32_bf16 v[144:159], v[52:55], v[104:111], v6
    v_exp_f32 v114, v114
    s_mov_b64 exec, s[40:41]
    ds_read_b128 v[48:51], v5 offset:4608
    ds_read_b128 v[52:55], v5 offset:5184
    s_mov_b64 exec, -1
    v_exp_f32 v115, v115
    v_exp_f32 v116, v116
    v_exp_f32 v117, v117
    v_mfma_f32_32x32x16_bf16 v[96:111], v[34:37], v[20:23], 0
    v_exp_f32 v118, v118
    v_exp_f32 v119, v119
    v_exp_f32 v120, v120
    v_exp_f32 v121, v121
    v_mfma_f32_32x32x8bf16_1k v[96:111], v[42:43], v[30:31], v[96:111]
    v_exp_f32 v122, v122
    v_exp_f32 v123, v123
    v_exp_f32 v124, v124
    v_exp_f32 v125, v125
    v_smfmac_f32_32x32x32_bf16 v[144:159], v[56:59], v[112:119], v6
    v_exp_f32 v126, v126
    v_exp_f32 v127, v127
    s_setprio 1
    v_exp_f32 v64, v64
    v_exp_f32 v65, v65
    v_smfmac_f32_32x32x32_bf16 v[128:143], v[60:63], v[88:95], v6
    v_exp_f32 v66, v66
    v_exp_f32 v67, v67
    v_exp_f32 v68, v68
    s_waitcnt lgkmcnt(0)
    v_exp_f32 v69, v69
    v_mfma_f32_32x32x16_bf16 v[80:95], v[38:41], v[16:19], 0
    v_exp_f32 v70, v70
    v_exp_f32 v71, v71
    ds_read_b128 v[34:37], v3 offset:8192
    v_exp_f32 v72, v72
    v_exp_f32 v73, v73
    v_mfma_f32_32x32x8bf16_1k v[80:95], v[44:45], v[28:29], v[80:95]
    v_exp_f32 v74, v74
    ds_read_b64 v[42:43], v4 offset:2048
    v_exp_f32 v75, v75
    v_exp_f32 v76, v76
    v_exp_f32 v77, v77
    v_smfmac_f32_32x32x32_bf16 v[128:143], v[48:51], v[64:71], v6
    v_exp_f32 v78, v78
    v_exp_f32 v79, v79
    s_setprio 0
    v_exp_f32 v96, v96
    v_exp_f32 v97, v97
    v_smfmac_f32_32x32x32_bf16 v[144:159], v[60:63], v[120:127], v6
    v_exp_f32 v98, v98
    s_mov_b64 exec, s[40:41]
    ds_read_b128 v[56:59], v5 offset:6912
    ds_read_b128 v[60:63], v5 offset:7488
    s_mov_b64 exec, -1
    v_exp_f32 v99, v99
    v_exp_f32 v100, v100
    v_exp_f32 v101, v101
    v_mfma_f32_32x32x16_bf16 v[112:127], v[38:41], v[20:23], 0
    v_exp_f32 v102, v102
    v_exp_f32 v103, v103
    v_exp_f32 v104, v104
    v_exp_f32 v105, v105
    v_mfma_f32_32x32x8bf16_1k v[112:127], v[44:45], v[30:31], v[112:127]
    v_exp_f32 v106, v106
    v_exp_f32 v107, v107
    v_exp_f32 v108, v108
    v_exp_f32 v109, v109
    v_smfmac_f32_32x32x32_bf16 v[144:159], v[48:51], v[96:103], v6
    v_exp_f32 v110, v110
    v_exp_f32 v111, v111
    s_setprio 1
    v_exp_f32 v80, v80
    v_exp_f32 v81, v81
    v_smfmac_f32_32x32x32_bf16 v[128:143], v[52:55], v[72:79], v6
    v_exp_f32 v82, v82
    v_exp_f32 v83, v83
    v_exp_f32 v84, v84
    s_waitcnt lgkmcnt(0)
    v_exp_f32 v85, v85
    v_mfma_f32_32x32x16_bf16 v[64:79], v[34:37], v[16:19], 0
    v_exp_f32 v86, v86
    v_exp_f32 v87, v87
    ds_read_b128 v[38:41], v3 offset:10240
    v_exp_f32 v88, v88
    v_exp_f32 v89, v89
    v_mfma_f32_32x32x8bf16_1k v[64:79], v[42:43], v[28:29], v[64:79]
    v_exp_f32 v90, v90
    ds_read_b64 v[44:45], v4 offset:2560
    v_exp_f32 v91, v91
    v_exp_f32 v92, v92
    v_exp_f32 v93, v93
    v_smfmac_f32_32x32x32_bf16 v[128:143], v[56:59], v[80:87], v6
    v_exp_f32 v94, v94
    v_exp_f32 v95, v95
    s_setprio 0
    v_exp_f32 v112, v112
    v_exp_f32 v113, v113
    v_smfmac_f32_32x32x32_bf16 v[144:159], v[52:55], v[104:111], v6
    v_exp_f32 v114, v114
    s_mov_b64 exec, s[40:41]
    ds_read_b128 v[48:51], v5 offset:9216
    ds_read_b128 v[52:55], v5 offset:9792
    s_mov_b64 exec, -1
    v_exp_f32 v115, v115
    v_exp_f32 v116, v116
    v_exp_f32 v117, v117
    v_mfma_f32_32x32x16_bf16 v[96:111], v[34:37], v[20:23], 0
    v_exp_f32 v118, v118
    v_exp_f32 v119, v119
    v_exp_f32 v120, v120
    v_exp_f32 v121, v121
    v_mfma_f32_32x32x8bf16_1k v[96:111], v[42:43], v[30:31], v[96:111]
    v_exp_f32 v122, v122
    v_exp_f32 v123, v123
    v_exp_f32 v124, v124
    v_exp_f32 v125, v125
    v_smfmac_f32_32x32x32_bf16 v[144:159], v[56:59], v[112:119], v6
    v_exp_f32 v126, v126
    v_exp_f32 v127, v127
    v_add_u32 v3, 8192, v3
    v_add_u32 v4, 2048, v4
    v_add_u32 v5, 9216, v5
    s_add_u32 s47, s47, 1
    s_cmp_lt_u32 s47, 8
    s_cbranch_scc1 K2_ALOOP
    v_smfmac_f32_32x32x32_bf16 v[128:143], v[60:63], v[88:95], v6
    v_smfmac_f32_32x32x32_bf16 v[144:159], v[60:63], v[120:127], v6
    s_setprio 0
    s_mul_i32 s24, s19, 3072
    v_add_u32 v12, s24, v2
    s_xor_b32 s25, s19, 4
    s_mul_i32 s25, s25, 3072
    v_add_u32 v13, s25, v2
    s_waitcnt lgkmcnt(0)
    s_nop 7
    s_nop 3
    s_cmp_eq_u32 s21, 0
    s_cbranch_scc0 K2_XB
    ds_write_b128 v12, v[144:147] offset:0
    ds_write_b128 v12, v[148:151] offset:1024
    ds_write_b128 v12, v[152:155] offset:2048
    s_branch K2_XJ
K2_XB:
    ds_write_b128 v12, v[128:131] offset:0
    ds_write_b128 v12, v[132:135] offset:1024
    ds_write_b128 v12, v[136:139] offset:2048
    s_nop 2
    v_mov_b32 v128, v144
    v_mov_b32 v129, v145
    v_mov_b32 v130, v146
    v_mov_b32 v131, v147
    v_mov_b32 v132, v148
    v_mov_b32 v133, v149
    v_mov_b32 v134, v150
    v_mov_b32 v135, v151
    v_mov_b32 v136, v152
    v_mov_b32 v137, v153
    v_mov_b32 v138, v154
    v_mov_b32 v139, v155
    v_mov_b32 v16, v20
    v_mov_b32 v17, v21
    v_mov_b32 v18, v22
    v_mov_b32 v19, v23
    v_mov_b32 v28, v30
K2_XJ:
    s_waitcnt lgkmcnt(0)
    s_barrier
    ds_read_b128 v[144:147], v13 offset:0
    ds_read_b128 v[148:151], v13 offset:1024
    ds_read_b128 v[152:155], v13 offset:2048
    s_mov_b32 s56, s4
    s_mov_b32 s57, s5
    s_mov_b32 s58, 229376
    s_mov_b32 s59, 0x00020000
    s_mov_b32 s48, 1
    s_mov_b32 s49, 0
    s_mov_b32 s50, 63
    s_mov_b32 s51, -1
    s_mov_b32 s52, -1
    s_waitcnt lgkmcnt(0)
    v_add_f32 v128, v128, v144
    v_add_f32 v129, v129, v145
    v_add_f32 v130, v130, v146
    v_add_f32 v131, v131, v147
    v_add_f32 v132, v132, v148
    v_add_f32 v133, v133, v149
    v_add_f32 v134, v134, v150
    v_add_f32 v135, v135, v151
    v_add_f32 v136, v136, v152
    v_add_f32 v137, v137, v153
    v_add_f32 v138, v138, v154
    v_mov_b32 v7, v138
    v_mov_b32 v8, v138
    v_mul_f32 v9, 0, v128
    s_nop 0
    v_permlane32_swap_b32 v7, v8
    v_fmac_f32 v9, 0, v129
    v_fmac_f32 v9, 0, v130
    v_fmac_f32 v9, 0, v131
    v_fmac_f32 v9, 0, v132
    v_fmac_f32 v9, 0, v133
    v_fmac_f32 v9, 0, v134
    v_fmac_f32 v9, 0, v135
    v_fmac_f32 v9, 0, v136
    v_fmac_f32 v9, 0, v137
    v_add_f32 v9, v7, v9
    s_mov_b32 s3, 0x0d800000
    v_cmp_le_f32 vcc, s3, v9
    s_mov_b32 s3, 0x79000000
    v_cmp_ge_f32 s[44:45], s3, v9
    v_rcp_f32 v7, v7
    s_nop 2
    s_and_b64 vcc, vcc, s[44:45]
    s_cmp_eq_u64 vcc, -1
    s_cbranch_scc0 K2_SLOWA
K2_DONEA:
    v_mul_f32 v128, v7, v128
    v_mul_f32 v129, v7, v129
    v_mul_f32 v130, v7, v130
    v_mul_f32 v131, v7, v131
    v_mul_f32 v132, v7, v132
    v_mul_f32 v133, v7, v133
    v_mul_f32 v134, v7, v134
    v_mul_f32 v135, v7, v135
    v_mul_f32 v136, v7, v136
    v_mul_f32 v137, v7, v137
    v_cvt_pk_bf16_f32 v192, v128, v129
    v_cvt_pk_bf16_f32 v193, v130, v131
    v_cvt_pk_bf16_f32 v194, v132, v133
    v_cvt_pk_bf16_f32 v195, v134, v135
    v_cvt_pk_bf16_f32 v196, v136, v137
    s_nop 0
    v_permlane32_swap_b32 v192, v194
    v_permlane32_swap_b32 v193, v195
    buffer_store_dwordx4 v[192:195], v197, s[12:15], 0 offen sc1
    s_mov_b64 exec, s[42:43]
    buffer_store_dword v196, v198, s[12:15], 0 offen
K2_END:
    s_endpgm
K2_SLOWB:
    v_and_b32 v33, 0xffff0000, v33
    s_branch K2_SLOW
K2_SLOWA:
    v_mov_b32 v24, v16
    v_mov_b32 v25, v17
    v_mov_b32 v26, v18
    v_mov_b32 v27, v19
    v_mov_b32 v32, v28
    v_mov_b32 v33, 0
K2_SLOW:
    v_mov_b32 v10, 0xff7fffff
    v_mov_b32 v128, 0
    v_mov_b32 v129, 0
    v_mov_b32 v130, 0
    v_mov_b32 v131, 0
    v_mov_b32 v132, 0
    v_mov_b32 v133, 0
    v_mov_b32 v134, 0
    v_mov_b32 v135, 0
    v_mov_b32 v136, 0
    v_mov_b32 v137, 0
    v_mov_b32 v138, 0
    v_mov_b32 v139, 0
    v_mov_b32 v140, 0
    v_mov_b32 v141, 0
    v_mov_b32 v142, 0
    v_mov_b32 v143, 0
    s_mov_b32 s46, s49
K2_SL0:
    s_lshl_b32 s47, s46, 10
    s_add_u32 s47, s47, 73728
    buffer_load_dwordx4 v[34:37], v2, s[56:59], s47 offen
    s_lshl_b32 s47, s46, 8
    s_add_u32 s47, s47, 139264
    buffer_load_dwordx2 v[42:43], v206, s[56:59], s47 offen
    s_waitcnt vmcnt(0)
    s_cmp_eq_u32 s46, s51
    s_cbranch_scc1 K2_SL0_F
    s_cmp_eq_u32 s46, s52
    s_cbranch_scc1 K2_SL0_L
    v_mfma_f32_32x32x16_bf16 v[64:79], v[34:37], v[24:27], 0
    s_branch K2_SL0_J
K2_SL0_F:
    v_mfma_f32_32x32x16_bf16 v[64:79], v[34:37], v[24:27], v[160:175]
    s_branch K2_SL0_J
K2_SL0_L:
    v_mfma_f32_32x32x16_bf16 v[64:79], v[34:37], v[24:27], v[176:191]
K2_SL0_J:
    v_mfma_f32_32x32x8bf16_1k v[64:79], v[42:43], v[32:33], v[64:79]
    s_nop 7
    s_nop 7
    v_max3_f32 v10, v64, v65, v10
    v_max3_f32 v10, v66, v67, v10
    v_max3_f32 v10, v68, v69, v10
    v_max3_f32 v10, v70, v71, v10
    v_max3_f32 v10, v72, v73, v10
    v_max3_f32 v10, v74, v75, v10
    v_max3_f32 v10, v76, v77, v10
    v_max3_f32 v10, v78, v79, v10
    s_add_u32 s46, s46, 1
    s_cmp_le_u32 s46, s50
    s_cbranch_scc1 K2_SL0
    v_mov_b32 v11, v10
    s_nop 1
    v_permlane32_swap_b32 v10, v11
    s_nop 1
    v_max_f32 v10, v10, v11
    s_mov_b32 s46, s49
K2_SL1:
    s_lshl_b32 s47, s46, 10
    s_add_u32 s47, s47, 73728
    buffer_load_dwordx4 v[34:37], v2, s[56:59], s47 offen
    s_lshl_b32 s47, s46, 8
    s_add_u32 s47, s47, 139264
    buffer_load_dwordx2 v[42:43], v206, s[56:59], s47 offen
    s_mul_i32 s47, s46, 1152
    s_add_u32 s47, s47, 155648
    s_mov_b64 exec, s[40:41]
    buffer_load_dwordx4 v[48:51], v207, s[56:59], s47 offen
    buffer_load_dwordx4 v[52:55], v207, s[56:59], s47 offen offset:576
    s_mov_b64 exec, -1
    s_waitcnt vmcnt(0)
    s_cmp_eq_u32 s46, s51
    s_cbranch_scc1 K2_SL1_F
    s_cmp_eq_u32 s46, s52
    s_cbranch_scc1 K2_SL1_L
    v_mfma_f32_32x32x16_bf16 v[64:79], v[34:37], v[24:27], 0
    s_branch K2_SL1_J
K2_SL1_F:
    v_mfma_f32_32x32x16_bf16 v[64:79], v[34:37], v[24:27], v[160:175]
    s_branch K2_SL1_J
K2_SL1_L:
    v_mfma_f32_32x32x16_bf16 v[64:79], v[34:37], v[24:27], v[176:191]
K2_SL1_J:
    v_mfma_f32_32x32x8bf16_1k v[64:79], v[42:43], v[32:33], v[64:79]
    s_nop 7
    s_nop 7
    v_sub_f32 v64, v64, v10
    v_sub_f32 v65, v65, v10
    v_sub_f32 v66, v66, v10
    v_sub_f32 v67, v67, v10
    v_sub_f32 v68, v68, v10
    v_sub_f32 v69, v69, v10
    v_sub_f32 v70, v70, v10
    v_sub_f32 v71, v71, v10
    v_sub_f32 v72, v72, v10
    v_sub_f32 v73, v73, v10
    v_sub_f32 v74, v74, v10
    v_sub_f32 v75, v75, v10
    v_sub_f32 v76, v76, v10
    v_sub_f32 v77, v77, v10
    v_sub_f32 v78, v78, v10
    v_sub_f32 v79, v79, v10
    v_exp_f32 v64, v64
    v_exp_f32 v65, v65
    v_exp_f32 v66, v66
    v_exp_f32 v67, v67
    v_exp_f32 v68, v68
    v_exp_f32 v69, v69
    v_exp_f32 v70, v70
    v_exp_f32 v71, v71
    v_exp_f32 v72, v72
    v_exp_f32 v73, v73
    v_exp_f32 v74, v74
    v_exp_f32 v75, v75
    v_exp_f32 v76, v76
    v_exp_f32 v77, v77
    v_exp_f32 v78, v78
    v_exp_f32 v79, v79
    s_nop 1
    v_smfmac_f32_32x32x32_bf16 v[128:143], v[48:51], v[64:71], v6
    v_smfmac_f32_32x32x32_bf16 v[128:143], v[52:55], v[72:79], v6
    s_nop 7
    s_nop 7
    s_add_u32 s46, s46, 1
    s_cmp_le_u32 s46, s50
    s_cbranch_scc1 K2_SL1
    v_mov_b32 v7, v138
    v_mov_b32 v8, v138
    s_nop 1
    v_permlane32_swap_b32 v7, v8
    s_nop 1
    v_rcp_f32 v7, v7
    s_nop 1
    s_cmp_eq_u32 s48, 0
    s_cbranch_scc1 K2_DONEB
    s_branch K2_DONEA
.globl proj_kernel
.p2align 8
.type proj_kernel,@function
proj_kernel:
    s_cmp_ge_u32 s2, 192
    s_cbranch_scc1 K3_END
    s_load_dwordx2 s[24:25], s[0:1], 16
    s_load_dwordx2 s[26:27], s[0:1], 40
    s_load_dwordx2 s[28:29], s[0:1], 48
    s_load_dwordx2 s[32:33], s[0:1], 64
    v_lshrrev_b32 v1, 6, v0
    v_and_b32 v2, 63, v0
    s_and_b32 s16, s2, 1
    s_and_b32 s3, s2, 7
    v_readfirstlane_b32 s19, v1
    s_lshr_b32 s3, s3, 1
    s_lshl_b32 s3, s3, 2
    s_lshr_b32 s20, s2, 3
    s_and_b32 s17, s20, 3
    s_add_u32 s17, s17, s3
    s_lshr_b32 s18, s20, 2
    s_waitcnt lgkmcnt(0)
    s_mul_i32 s3, s16, 2359296
    s_add_u32 s3, s3, 14680064
    s_add_u32 s34, s32, s3
    s_addc_u32 s35, s33, 0
    s_mov_b32 s4, s34
    s_mov_b32 s5, s35
    s_mov_b32 s6, 2359296
    s_mov_b32 s7, 0x00020000
    s_cmp_eq_u32 s16, 0
    s_cselect_b32 s36, s24, s26
    s_cselect_b32 s37, s25, s27
    s_mov_b32 s8, s36
    s_mov_b32 s9, s37
    s_mov_b32 s10, 663552
    s_mov_b32 s11, 0x00020000
    s_cmp_ge_u32 s19, 4
    s_cbranch_scc1 K3_LOAD
    s_mov_b32 s12, s28
    s_mov_b32 s13, s29
    s_mov_b32 s14, 4718592
    s_mov_b32 s15, 0x00020000
    v_and_b32 v3, 15, v2
    v_lshrrev_b32 v4, 4, v2
    s_lshl_b32 s3, s19, 5
    v_add_u32 v6, s3, v3
    v_lshrrev_b32 v5, 3, v6
    v_lshlrev_b32 v5, 10, v5
    v_bfe_u32 v7, v2, 1, 2
    v_lshl_add_u32 v5, v7, 8, v5
    v_lshrrev_b32 v13, 1, v4
    v_xor_b32 v7, v7, v13
    v_lshl_add_u32 v5, v7, 6, v5
    v_and_b32 v7, 1, v2
    v_lshl_add_u32 v5, v7, 5, v5
    v_and_b32 v7, 1, v4
    v_lshl_add_u32 v8, v7, 4, v5
    v_xor_b32 v9, 128, v8
    v_mul_u32_u24 v7, 2112, v4
    v_lshl_add_u32 v12, v6, 2, v7
    v_and_b32 v5, 1, v4
    v_mul_u32_u24 v5, 3104, v5
    v_lshrrev_b32 v7, 1, v4
    v_mul_u32_u24 v7, 1536, v7
    v_add_u32 v5, v5, v7
    v_bfe_u32 v7, v2, 2, 2
    v_mul_u32_u24 v7, 192, v7
    v_add_u32 v5, v5, v7
    v_and_b32 v7, 3, v2
    v_lshl_add_u32 v5, v7, 3, v5
    v_add_u32 v10, 16896, v5
    v_mul_u32_u24 v11, 2304, v3
    v_lshl_add_u32 v11, v4, 4, v11
    s_lshl_b32 s22, s17, 2
    s_add_u32 s22, s22, s19
    s_mul_i32 s22, s22, 73728
    s_mul_i32 s3, s16, 1152
    s_add_u32 s22, s22, s3
    s_mul_i32 s3, s18, 192
    s_add_u32 s22, s22, s3
    s_barrier
    ds_read_b128 v[16:19], v8 offset:0
    ds_read_b64_tr_b16 v[32:33], v10 offset:0
    ds_read_b64_tr_b16 v[34:35], v10 offset:768
    ds_read_b128 v[20:23], v8 offset:2048
    ds_read_b64_tr_b16 v[36:37], v10 offset:32
    ds_read_b64_tr_b16 v[38:39], v10 offset:800
    ds_read_b64_tr_b16 v[40:41], v10 offset:64
    ds_read_b64_tr_b16 v[42:43], v10 offset:832
    ds_read_b64_tr_b16 v[44:45], v10 offset:96
    ds_read_b64_tr_b16 v[46:47], v10 offset:864
    ds_read_b64_tr_b16 v[48:49], v10 offset:128
    ds_read_b64_tr_b16 v[50:51], v10 offset:896
    ds_read_b64_tr_b16 v[52:53], v10 offset:160
    ds_read_b64_tr_b16 v[54:55], v10 offset:928
    s_waitcnt lgkmcnt(0)
    v_mfma_f32_16x16x32_bf16 v[80:83], v[32:35], v[16:19], 0
    ds_read_b128 v[24:27], v9 offset:0
    ds_read_b64_tr_b16 v[56:57], v10 offset:6208
    v_mfma_f32_16x16x32_bf16 v[84:87], v[32:35], v[20:23], 0
    ds_read_b64_tr_b16 v[58:59], v10 offset:6976
    ds_read_b128 v[28:31], v9 offset:2048
    v_mfma_f32_16x16x32_bf16 v[88:91], v[36:39], v[16:19], 0
    ds_read_b64_tr_b16 v[60:61], v10 offset:6240
    ds_read_b64_tr_b16 v[62:63], v10 offset:7008
    v_mfma_f32_16x16x32_bf16 v[92:95], v[36:39], v[20:23], 0
    ds_read_b64_tr_b16 v[64:65], v10 offset:6272
    ds_read_b64_tr_b16 v[66:67], v10 offset:7040
    v_mfma_f32_16x16x32_bf16 v[96:99], v[40:43], v[16:19], 0
    ds_read_b64_tr_b16 v[68:69], v10 offset:6304
    ds_read_b64_tr_b16 v[70:71], v10 offset:7072
    v_mfma_f32_16x16x32_bf16 v[100:103], v[40:43], v[20:23], 0
    ds_read_b64_tr_b16 v[72:73], v10 offset:6336
    ds_read_b64_tr_b16 v[74:75], v10 offset:7104
    v_mfma_f32_16x16x32_bf16 v[104:107], v[44:47], v[16:19], 0
    ds_read_b64_tr_b16 v[76:77], v10 offset:6368
    ds_read_b64_tr_b16 v[78:79], v10 offset:7136
    v_mfma_f32_16x16x32_bf16 v[108:111], v[44:47], v[20:23], 0
    v_mfma_f32_16x16x32_bf16 v[112:115], v[48:51], v[16:19], 0
    v_mfma_f32_16x16x32_bf16 v[116:119], v[48:51], v[20:23], 0
    v_mfma_f32_16x16x32_bf16 v[120:123], v[52:55], v[16:19], 0
    v_mfma_f32_16x16x32_bf16 v[124:127], v[52:55], v[20:23], 0
    s_waitcnt lgkmcnt(0)
    s_barrier
    v_mfma_f32_16x16x32_bf16 v[80:83], v[56:59], v[24:27], v[80:83]
    v_add_u32 v8, 0x00007280, v8
    v_add_u32 v10, 0x00007280, v10
    v_mfma_f32_16x16x32_bf16 v[84:87], v[56:59], v[28:31], v[84:87]
    v_add_u32 v12, 0x00007280, v12
    ds_read_b128 v[16:19], v8 offset:0
    v_mfma_f32_16x16x32_bf16 v[88:91], v[60:63], v[24:27], v[88:91]
    ds_read_b64_tr_b16 v[32:33], v10 offset:0
    ds_read_b64_tr_b16 v[34:35], v10 offset:768
    v_mfma_f32_16x16x32_bf16 v[92:95], v[60:63], v[28:31], v[92:95]
    ds_read_b128 v[20:23], v8 offset:2048
    ds_read_b64_tr_b16 v[36:37], v10 offset:32
    v_mfma_f32_16x16x32_bf16 v[96:99], v[64:67], v[24:27], v[96:99]
    ds_read_b64_tr_b16 v[38:39], v10 offset:800
    ds_read_b64_tr_b16 v[40:41], v10 offset:64
    v_mfma_f32_16x16x32_bf16 v[100:103], v[64:67], v[28:31], v[100:103]
    ds_read_b64_tr_b16 v[42:43], v10 offset:832
    ds_read_b64_tr_b16 v[44:45], v10 offset:96
    v_mfma_f32_16x16x32_bf16 v[104:107], v[68:71], v[24:27], v[104:107]
    ds_read_b64_tr_b16 v[46:47], v10 offset:864
    ds_read_b64_tr_b16 v[48:49], v10 offset:128
    v_mfma_f32_16x16x32_bf16 v[108:111], v[68:71], v[28:31], v[108:111]
    ds_read_b64_tr_b16 v[50:51], v10 offset:896
    ds_read_b64_tr_b16 v[52:53], v10 offset:160
    v_mfma_f32_16x16x32_bf16 v[112:115], v[72:75], v[24:27], v[112:115]
    ds_read_b64_tr_b16 v[54:55], v10 offset:928
    v_add_u32 v9, 0x00007280, v9
    v_mfma_f32_16x16x32_bf16 v[116:119], v[72:75], v[28:31], v[116:119]
    v_mfma_f32_16x16x32_bf16 v[120:123], v[76:79], v[24:27], v[120:123]
    v_mfma_f32_16x16x32_bf16 v[124:127], v[76:79], v[28:31], v[124:127]
    s_waitcnt lgkmcnt(0)
    v_mfma_f32_16x16x32_bf16 v[80:83], v[32:35], v[16:19], v[80:83]
    ds_read_b128 v[24:27], v9 offset:0
    ds_read_b64_tr_b16 v[56:57], v10 offset:6208
    v_mfma_f32_16x16x32_bf16 v[84:87], v[32:35], v[20:23], v[84:87]
    ds_read_b64_tr_b16 v[58:59], v10 offset:6976
    ds_read_b128 v[28:31], v9 offset:2048
    v_mfma_f32_16x16x32_bf16 v[88:91], v[36:39], v[16:19], v[88:91]
    ds_read_b64_tr_b16 v[60:61], v10 offset:6240
    ds_read_b64_tr_b16 v[62:63], v10 offset:7008
    v_mfma_f32_16x16x32_bf16 v[92:95], v[36:39], v[20:23], v[92:95]
    ds_read_b64_tr_b16 v[64:65], v10 offset:6272
    ds_read_b64_tr_b16 v[66:67], v10 offset:7040
    v_mfma_f32_16x16x32_bf16 v[96:99], v[40:43], v[16:19], v[96:99]
    ds_read_b64_tr_b16 v[68:69], v10 offset:6304
    ds_read_b64_tr_b16 v[70:71], v10 offset:7072
    v_mfma_f32_16x16x32_bf16 v[100:103], v[40:43], v[20:23], v[100:103]
    ds_read_b64_tr_b16 v[72:73], v10 offset:6336
    ds_read_b64_tr_b16 v[74:75], v10 offset:7104
    v_mfma_f32_16x16x32_bf16 v[104:107], v[44:47], v[16:19], v[104:107]
    ds_read_b64_tr_b16 v[76:77], v10 offset:6368
    ds_read_b64_tr_b16 v[78:79], v10 offset:7136
    v_mfma_f32_16x16x32_bf16 v[108:111], v[44:47], v[20:23], v[108:111]
    v_mfma_f32_16x16x32_bf16 v[112:115], v[48:51], v[16:19], v[112:115]
    v_mfma_f32_16x16x32_bf16 v[116:119], v[48:51], v[20:23], v[116:119]
    v_mfma_f32_16x16x32_bf16 v[120:123], v[52:55], v[16:19], v[120:123]
    v_mfma_f32_16x16x32_bf16 v[124:127], v[52:55], v[20:23], v[124:127]
    s_waitcnt lgkmcnt(0)
    s_barrier
    v_mfma_f32_16x16x32_bf16 v[80:83], v[56:59], v[24:27], v[80:83]
    v_add_u32 v8, 0x00007280, v8
    v_add_u32 v10, 0x00007280, v10
    v_mfma_f32_16x16x32_bf16 v[84:87], v[56:59], v[28:31], v[84:87]
    v_add_u32 v12, 0x00007280, v12
    ds_read_b128 v[16:19], v8 offset:0
    v_mfma_f32_16x16x32_bf16 v[88:91], v[60:63], v[24:27], v[88:91]
    ds_read_b64_tr_b16 v[32:33], v10 offset:0
    ds_read_b64_tr_b16 v[34:35], v10 offset:768
    v_mfma_f32_16x16x32_bf16 v[92:95], v[60:63], v[28:31], v[92:95]
    ds_read_b128 v[20:23], v8 offset:2048
    ds_read_b64_tr_b16 v[36:37], v10 offset:32
    v_mfma_f32_16x16x32_bf16 v[96:99], v[64:67], v[24:27], v[96:99]
    ds_read_b64_tr_b16 v[38:39], v10 offset:800
    ds_read_b64_tr_b16 v[40:41], v10 offset:64
    v_mfma_f32_16x16x32_bf16 v[100:103], v[64:67], v[28:31], v[100:103]
    ds_read_b64_tr_b16 v[42:43], v10 offset:832
    ds_read_b64_tr_b16 v[44:45], v10 offset:96
    v_mfma_f32_16x16x32_bf16 v[104:107], v[68:71], v[24:27], v[104:107]
    ds_read_b64_tr_b16 v[46:47], v10 offset:864
    ds_read_b64_tr_b16 v[48:49], v10 offset:128
    v_mfma_f32_16x16x32_bf16 v[108:111], v[68:71], v[28:31], v[108:111]
    ds_read_b64_tr_b16 v[50:51], v10 offset:896
    ds_read_b64_tr_b16 v[52:53], v10 offset:160
    v_mfma_f32_16x16x32_bf16 v[112:115], v[72:75], v[24:27], v[112:115]
    ds_read_b64_tr_b16 v[54:55], v10 offset:928
    v_add_u32 v9, 0x00007280, v9
    v_mfma_f32_16x16x32_bf16 v[116:119], v[72:75], v[28:31], v[116:119]
    v_mfma_f32_16x16x32_bf16 v[120:123], v[76:79], v[24:27], v[120:123]
    v_mfma_f32_16x16x32_bf16 v[124:127], v[76:79], v[28:31], v[124:127]
    s_waitcnt lgkmcnt(0)
    v_mfma_f32_16x16x32_bf16 v[80:83], v[32:35], v[16:19], v[80:83]
    ds_read_b128 v[24:27], v9 offset:0
    ds_read_b64_tr_b16 v[56:57], v10 offset:6208
    v_mfma_f32_16x16x32_bf16 v[84:87], v[32:35], v[20:23], v[84:87]
    ds_read_b64_tr_b16 v[58:59], v10 offset:6976
    ds_read_b128 v[28:31], v9 offset:2048
    v_mfma_f32_16x16x32_bf16 v[88:91], v[36:39], v[16:19], v[88:91]
    ds_read_b64_tr_b16 v[60:61], v10 offset:6240
    ds_read_b64_tr_b16 v[62:63], v10 offset:7008
    v_mfma_f32_16x16x32_bf16 v[92:95], v[36:39], v[20:23], v[92:95]
    ds_read_b64_tr_b16 v[64:65], v10 offset:6272
    ds_read_b64_tr_b16 v[66:67], v10 offset:7040
    v_mfma_f32_16x16x32_bf16 v[96:99], v[40:43], v[16:19], v[96:99]
    ds_read_b64_tr_b16 v[68:69], v10 offset:6304
    ds_read_b64_tr_b16 v[70:71], v10 offset:7072
    v_mfma_f32_16x16x32_bf16 v[100:103], v[40:43], v[20:23], v[100:103]
    ds_read_b64_tr_b16 v[72:73], v10 offset:6336
    ds_read_b64_tr_b16 v[74:75], v10 offset:7104
    v_mfma_f32_16x16x32_bf16 v[104:107], v[44:47], v[16:19], v[104:107]
    ds_read_b64_tr_b16 v[76:77], v10 offset:6368
    ds_read_b64_tr_b16 v[78:79], v10 offset:7136
    v_mfma_f32_16x16x32_bf16 v[108:111], v[44:47], v[20:23], v[108:111]
    v_mfma_f32_16x16x32_bf16 v[112:115], v[48:51], v[16:19], v[112:115]
    v_mfma_f32_16x16x32_bf16 v[116:119], v[48:51], v[20:23], v[116:119]
    v_mfma_f32_16x16x32_bf16 v[120:123], v[52:55], v[16:19], v[120:123]
    v_mfma_f32_16x16x32_bf16 v[124:127], v[52:55], v[20:23], v[124:127]
    s_waitcnt lgkmcnt(0)
    s_barrier
    v_mfma_f32_16x16x32_bf16 v[80:83], v[56:59], v[24:27], v[80:83]
    v_add_u32 v8, 0x00007280, v8
    v_add_u32 v10, 0x00007280, v10
    v_mfma_f32_16x16x32_bf16 v[84:87], v[56:59], v[28:31], v[84:87]
    v_add_u32 v12, 0x00007280, v12
    ds_read_b128 v[16:19], v8 offset:0
    v_mfma_f32_16x16x32_bf16 v[88:91], v[60:63], v[24:27], v[88:91]
    ds_read_b64_tr_b16 v[32:33], v10 offset:0
    ds_read_b64_tr_b16 v[34:35], v10 offset:768
    v_mfma_f32_16x16x32_bf16 v[92:95], v[60:63], v[28:31], v[92:95]
    ds_read_b128 v[20:23], v8 offset:2048
    ds_read_b64_tr_b16 v[36:37], v10 offset:32
    v_mfma_f32_16x16x32_bf16 v[96:99], v[64:67], v[24:27], v[96:99]
    ds_read_b64_tr_b16 v[38:39], v10 offset:800
    ds_read_b64_tr_b16 v[40:41], v10 offset:64
    v_mfma_f32_16x16x32_bf16 v[100:103], v[64:67], v[28:31], v[100:103]
    ds_read_b64_tr_b16 v[42:43], v10 offset:832
    ds_read_b64_tr_b16 v[44:45], v10 offset:96
    v_mfma_f32_16x16x32_bf16 v[104:107], v[68:71], v[24:27], v[104:107]
    ds_read_b64_tr_b16 v[46:47], v10 offset:864
    ds_read_b64_tr_b16 v[48:49], v10 offset:128
    v_mfma_f32_16x16x32_bf16 v[108:111], v[68:71], v[28:31], v[108:111]
    ds_read_b64_tr_b16 v[50:51], v10 offset:896
    ds_read_b64_tr_b16 v[52:53], v10 offset:160
    v_mfma_f32_16x16x32_bf16 v[112:115], v[72:75], v[24:27], v[112:115]
    ds_read_b64_tr_b16 v[54:55], v10 offset:928
    v_add_u32 v9, 0x00007280, v9
    v_mfma_f32_16x16x32_bf16 v[116:119], v[72:75], v[28:31], v[116:119]
    v_mfma_f32_16x16x32_bf16 v[120:123], v[76:79], v[24:27], v[120:123]
    v_mfma_f32_16x16x32_bf16 v[124:127], v[76:79], v[28:31], v[124:127]
    s_waitcnt lgkmcnt(0)
    v_mfma_f32_16x16x32_bf16 v[80:83], v[32:35], v[16:19], v[80:83]
    ds_read_b128 v[24:27], v9 offset:0
    ds_read_b64_tr_b16 v[56:57], v10 offset:6208
    v_mfma_f32_16x16x32_bf16 v[84:87], v[32:35], v[20:23], v[84:87]
    ds_read_b64_tr_b16 v[58:59], v10 offset:6976
    ds_read_b128 v[28:31], v9 offset:2048
    v_mfma_f32_16x16x32_bf16 v[88:91], v[36:39], v[16:19], v[88:91]
    ds_read_b64_tr_b16 v[60:61], v10 offset:6240
    ds_read_b64_tr_b16 v[62:63], v10 offset:7008
    v_mfma_f32_16x16x32_bf16 v[92:95], v[36:39], v[20:23], v[92:95]
    ds_read_b64_tr_b16 v[64:65], v10 offset:6272
    ds_read_b64_tr_b16 v[66:67], v10 offset:7040
    v_mfma_f32_16x16x32_bf16 v[96:99], v[40:43], v[16:19], v[96:99]
    ds_read_b64_tr_b16 v[68:69], v10 offset:6304
    ds_read_b64_tr_b16 v[70:71], v10 offset:7072
    v_mfma_f32_16x16x32_bf16 v[100:103], v[40:43], v[20:23], v[100:103]
    ds_read_b64_tr_b16 v[72:73], v10 offset:6336
    ds_read_b64_tr_b16 v[74:75], v10 offset:7104
    v_mfma_f32_16x16x32_bf16 v[104:107], v[44:47], v[16:19], v[104:107]
    ds_read_b64_tr_b16 v[76:77], v10 offset:6368
    ds_read_b64_tr_b16 v[78:79], v10 offset:7136
    v_mfma_f32_16x16x32_bf16 v[108:111], v[44:47], v[20:23], v[108:111]
    v_mfma_f32_16x16x32_bf16 v[112:115], v[48:51], v[16:19], v[112:115]
    v_mfma_f32_16x16x32_bf16 v[116:119], v[48:51], v[20:23], v[116:119]
    v_mfma_f32_16x16x32_bf16 v[120:123], v[52:55], v[16:19], v[120:123]
    v_mfma_f32_16x16x32_bf16 v[124:127], v[52:55], v[20:23], v[124:127]
    s_waitcnt lgkmcnt(0)
    s_barrier
    v_mfma_f32_16x16x32_bf16 v[80:83], v[56:59], v[24:27], v[80:83]
    v_add_u32 v8, 0xfffea880, v8
    v_add_u32 v10, 0xfffea880, v10
    v_mfma_f32_16x16x32_bf16 v[84:87], v[56:59], v[28:31], v[84:87]
    v_add_u32 v12, 0xfffea880, v12
    ds_read_b128 v[16:19], v8 offset:0
    v_mfma_f32_16x16x32_bf16 v[88:91], v[60:63], v[24:27], v[88:91]
    ds_read_b64_tr_b16 v[32:33], v10 offset:0
    ds_read_b64_tr_b16 v[34:35], v10 offset:768
    v_mfma_f32_16x16x32_bf16 v[92:95], v[60:63], v[28:31], v[92:95]
    ds_read_b128 v[20:23], v8 offset:2048
    ds_read_b64_tr_b16 v[36:37], v10 offset:32
    v_mfma_f32_16x16x32_bf16 v[96:99], v[64:67], v[24:27], v[96:99]
    ds_read_b64_tr_b16 v[38:39], v10 offset:800
    ds_read_b64_tr_b16 v[40:41], v10 offset:64
    v_mfma_f32_16x16x32_bf16 v[100:103], v[64:67], v[28:31], v[100:103]
    ds_read_b64_tr_b16 v[42:43], v10 offset:832
    ds_read_b64_tr_b16 v[44:45], v10 offset:96
    v_mfma_f32_16x16x32_bf16 v[104:107], v[68:71], v[24:27], v[104:107]
    ds_read_b64_tr_b16 v[46:47], v10 offset:864
    ds_read_b64_tr_b16 v[48:49], v10 offset:128
    v_mfma_f32_16x16x32_bf16 v[108:111], v[68:71], v[28:31], v[108:111]
    ds_read_b64_tr_b16 v[50:51], v10 offset:896
    ds_read_b64_tr_b16 v[52:53], v10 offset:160
    v_mfma_f32_16x16x32_bf16 v[112:115], v[72:75], v[24:27], v[112:115]
    ds_read_b64_tr_b16 v[54:55], v10 offset:928
    v_add_u32 v9, 0xfffea880, v9
    v_mfma_f32_16x16x32_bf16 v[116:119], v[72:75], v[28:31], v[116:119]
    v_mfma_f32_16x16x32_bf16 v[120:123], v[76:79], v[24:27], v[120:123]
    v_mfma_f32_16x16x32_bf16 v[124:127], v[76:79], v[28:31], v[124:127]
    s_waitcnt lgkmcnt(0)
    v_mfma_f32_16x16x32_bf16 v[80:83], v[32:35], v[16:19], v[80:83]
    ds_read_b128 v[24:27], v9 offset:0
    ds_read_b64_tr_b16 v[56:57], v10 offset:6208
    v_mfma_f32_16x16x32_bf16 v[84:87], v[32:35], v[20:23], v[84:87]
    ds_read_b64_tr_b16 v[58:59], v10 offset:6976
    ds_read_b128 v[28:31], v9 offset:2048
    v_mfma_f32_16x16x32_bf16 v[88:91], v[36:39], v[16:19], v[88:91]
    ds_read_b64_tr_b16 v[60:61], v10 offset:6240
    ds_read_b64_tr_b16 v[62:63], v10 offset:7008
    v_mfma_f32_16x16x32_bf16 v[92:95], v[36:39], v[20:23], v[92:95]
    ds_read_b64_tr_b16 v[64:65], v10 offset:6272
    ds_read_b64_tr_b16 v[66:67], v10 offset:7040
    v_mfma_f32_16x16x32_bf16 v[96:99], v[40:43], v[16:19], v[96:99]
    ds_read_b64_tr_b16 v[68:69], v10 offset:6304
    ds_read_b64_tr_b16 v[70:71], v10 offset:7072
    v_mfma_f32_16x16x32_bf16 v[100:103], v[40:43], v[20:23], v[100:103]
    ds_read_b64_tr_b16 v[72:73], v10 offset:6336
    ds_read_b64_tr_b16 v[74:75], v10 offset:7104
    v_mfma_f32_16x16x32_bf16 v[104:107], v[44:47], v[16:19], v[104:107]
    ds_read_b64_tr_b16 v[76:77], v10 offset:6368
    ds_read_b64_tr_b16 v[78:79], v10 offset:7136
    v_mfma_f32_16x16x32_bf16 v[108:111], v[44:47], v[20:23], v[108:111]
    v_mfma_f32_16x16x32_bf16 v[112:115], v[48:51], v[16:19], v[112:115]
    v_mfma_f32_16x16x32_bf16 v[116:119], v[48:51], v[20:23], v[116:119]
    v_mfma_f32_16x16x32_bf16 v[120:123], v[52:55], v[16:19], v[120:123]
    v_mfma_f32_16x16x32_bf16 v[124:127], v[52:55], v[20:23], v[124:127]
    s_waitcnt lgkmcnt(0)
    s_barrier
    v_mfma_f32_16x16x32_bf16 v[80:83], v[56:59], v[24:27], v[80:83]
    v_add_u32 v8, 0x00007280, v8
    v_add_u32 v10, 0x00007280, v10
    v_mfma_f32_16x16x32_bf16 v[84:87], v[56:59], v[28:31], v[84:87]
    v_add_u32 v12, 0x00007280, v12
    ds_read_b128 v[16:19], v8 offset:0
    v_mfma_f32_16x16x32_bf16 v[88:91], v[60:63], v[24:27], v[88:91]
    ds_read_b64_tr_b16 v[32:33], v10 offset:0
    ds_read_b64_tr_b16 v[34:35], v10 offset:768
    v_mfma_f32_16x16x32_bf16 v[92:95], v[60:63], v[28:31], v[92:95]
    ds_read_b128 v[20:23], v8 offset:2048
    ds_read_b64_tr_b16 v[36:37], v10 offset:32
    v_mfma_f32_16x16x32_bf16 v[96:99], v[64:67], v[24:27], v[96:99]
    ds_read_b64_tr_b16 v[38:39], v10 offset:800
    ds_read_b64_tr_b16 v[40:41], v10 offset:64
    v_mfma_f32_16x16x32_bf16 v[100:103], v[64:67], v[28:31], v[100:103]
    ds_read_b64_tr_b16 v[42:43], v10 offset:832
    ds_read_b64_tr_b16 v[44:45], v10 offset:96
    v_mfma_f32_16x16x32_bf16 v[104:107], v[68:71], v[24:27], v[104:107]
    ds_read_b64_tr_b16 v[46:47], v10 offset:864
    ds_read_b64_tr_b16 v[48:49], v10 offset:128
    v_mfma_f32_16x16x32_bf16 v[108:111], v[68:71], v[28:31], v[108:111]
    ds_read_b64_tr_b16 v[50:51], v10 offset:896
    ds_read_b64_tr_b16 v[52:53], v10 offset:160
    v_mfma_f32_16x16x32_bf16 v[112:115], v[72:75], v[24:27], v[112:115]
    ds_read_b64_tr_b16 v[54:55], v10 offset:928
    v_add_u32 v9, 0x00007280, v9
    v_mfma_f32_16x16x32_bf16 v[116:119], v[72:75], v[28:31], v[116:119]
    v_mfma_f32_16x16x32_bf16 v[120:123], v[76:79], v[24:27], v[120:123]
    v_mfma_f32_16x16x32_bf16 v[124:127], v[76:79], v[28:31], v[124:127]
    s_waitcnt lgkmcnt(0)
    v_mfma_f32_16x16x32_bf16 v[80:83], v[32:35], v[16:19], v[80:83]
    ds_read_b128 v[24:27], v9 offset:0
    ds_read_b64_tr_b16 v[56:57], v10 offset:6208
    v_mfma_f32_16x16x32_bf16 v[84:87], v[32:35], v[20:23], v[84:87]
    ds_read_b64_tr_b16 v[58:59], v10 offset:6976
    ds_read_b128 v[28:31], v9 offset:2048
    v_mfma_f32_16x16x32_bf16 v[88:91], v[36:39], v[16:19], v[88:91]
    ds_read_b64_tr_b16 v[60:61], v10 offset:6240
    ds_read_b64_tr_b16 v[62:63], v10 offset:7008
    v_mfma_f32_16x16x32_bf16 v[92:95], v[36:39], v[20:23], v[92:95]
    ds_read_b64_tr_b16 v[64:65], v10 offset:6272
    ds_read_b64_tr_b16 v[66:67], v10 offset:7040
    v_mfma_f32_16x16x32_bf16 v[96:99], v[40:43], v[16:19], v[96:99]
    ds_read_b64_tr_b16 v[68:69], v10 offset:6304
    ds_read_b64_tr_b16 v[70:71], v10 offset:7072
    v_mfma_f32_16x16x32_bf16 v[100:103], v[40:43], v[20:23], v[100:103]
    ds_read_b64_tr_b16 v[72:73], v10 offset:6336
    ds_read_b64_tr_b16 v[74:75], v10 offset:7104
    v_mfma_f32_16x16x32_bf16 v[104:107], v[44:47], v[16:19], v[104:107]
    ds_read_b64_tr_b16 v[76:77], v10 offset:6368
    ds_read_b64_tr_b16 v[78:79], v10 offset:7136
    v_mfma_f32_16x16x32_bf16 v[108:111], v[44:47], v[20:23], v[108:111]
    v_mfma_f32_16x16x32_bf16 v[112:115], v[48:51], v[16:19], v[112:115]
    v_mfma_f32_16x16x32_bf16 v[116:119], v[48:51], v[20:23], v[116:119]
    v_mfma_f32_16x16x32_bf16 v[120:123], v[52:55], v[16:19], v[120:123]
    v_mfma_f32_16x16x32_bf16 v[124:127], v[52:55], v[20:23], v[124:127]
    s_waitcnt lgkmcnt(0)
    s_barrier
    v_mfma_f32_16x16x32_bf16 v[80:83], v[56:59], v[24:27], v[80:83]
    v_add_u32 v8, 0x00007280, v8
    v_add_u32 v10, 0x00007280, v10
    v_mfma_f32_16x16x32_bf16 v[84:87], v[56:59], v[28:31], v[84:87]
    v_add_u32 v12, 0x00007280, v12
    ds_read_b128 v[16:19], v8 offset:0
    v_mfma_f32_16x16x32_bf16 v[88:91], v[60:63], v[24:27], v[88:91]
    ds_read_b64_tr_b16 v[32:33], v10 offset:0
    ds_read_b64_tr_b16 v[34:35], v10 offset:768
    v_mfma_f32_16x16x32_bf16 v[92:95], v[60:63], v[28:31], v[92:95]
    ds_read_b128 v[20:23], v8 offset:2048
    ds_read_b64_tr_b16 v[36:37], v10 offset:32
    v_mfma_f32_16x16x32_bf16 v[96:99], v[64:67], v[24:27], v[96:99]
    ds_read_b64_tr_b16 v[38:39], v10 offset:800
    ds_read_b64_tr_b16 v[40:41], v10 offset:64
    v_mfma_f32_16x16x32_bf16 v[100:103], v[64:67], v[28:31], v[100:103]
    ds_read_b64_tr_b16 v[42:43], v10 offset:832
    ds_read_b64_tr_b16 v[44:45], v10 offset:96
    v_mfma_f32_16x16x32_bf16 v[104:107], v[68:71], v[24:27], v[104:107]
    ds_read_b64_tr_b16 v[46:47], v10 offset:864
    ds_read_b64_tr_b16 v[48:49], v10 offset:128
    v_mfma_f32_16x16x32_bf16 v[108:111], v[68:71], v[28:31], v[108:111]
    ds_read_b64_tr_b16 v[50:51], v10 offset:896
    ds_read_b64_tr_b16 v[52:53], v10 offset:160
    v_mfma_f32_16x16x32_bf16 v[112:115], v[72:75], v[24:27], v[112:115]
    ds_read_b64_tr_b16 v[54:55], v10 offset:928
    v_add_u32 v9, 0x00007280, v9
    v_mfma_f32_16x16x32_bf16 v[116:119], v[72:75], v[28:31], v[116:119]
    v_mfma_f32_16x16x32_bf16 v[120:123], v[76:79], v[24:27], v[120:123]
    v_mfma_f32_16x16x32_bf16 v[124:127], v[76:79], v[28:31], v[124:127]
    s_waitcnt lgkmcnt(0)
    v_mfma_f32_16x16x32_bf16 v[80:83], v[32:35], v[16:19], v[80:83]
    ds_read_b128 v[24:27], v9 offset:0
    ds_read_b64_tr_b16 v[56:57], v10 offset:6208
    v_mfma_f32_16x16x32_bf16 v[84:87], v[32:35], v[20:23], v[84:87]
    ds_read_b64_tr_b16 v[58:59], v10 offset:6976
    ds_read_b128 v[28:31], v9 offset:2048
    v_mfma_f32_16x16x32_bf16 v[88:91], v[36:39], v[16:19], v[88:91]
    ds_read_b64_tr_b16 v[60:61], v10 offset:6240
    ds_read_b64_tr_b16 v[62:63], v10 offset:7008
    v_mfma_f32_16x16x32_bf16 v[92:95], v[36:39], v[20:23], v[92:95]
    ds_read_b64_tr_b16 v[64:65], v10 offset:6272
    ds_read_b64_tr_b16 v[66:67], v10 offset:7040
    v_mfma_f32_16x16x32_bf16 v[96:99], v[40:43], v[16:19], v[96:99]
    ds_read_b64_tr_b16 v[68:69], v10 offset:6304
    ds_read_b64_tr_b16 v[70:71], v10 offset:7072
    v_mfma_f32_16x16x32_bf16 v[100:103], v[40:43], v[20:23], v[100:103]
    ds_read_b64_tr_b16 v[72:73], v10 offset:6336
    ds_read_b64_tr_b16 v[74:75], v10 offset:7104
    v_mfma_f32_16x16x32_bf16 v[104:107], v[44:47], v[16:19], v[104:107]
    ds_read_b64_tr_b16 v[76:77], v10 offset:6368
    ds_read_b64_tr_b16 v[78:79], v10 offset:7136
    v_mfma_f32_16x16x32_bf16 v[108:111], v[44:47], v[20:23], v[108:111]
    v_mfma_f32_16x16x32_bf16 v[112:115], v[48:51], v[16:19], v[112:115]
    v_mfma_f32_16x16x32_bf16 v[116:119], v[48:51], v[20:23], v[116:119]
    v_mfma_f32_16x16x32_bf16 v[120:123], v[52:55], v[16:19], v[120:123]
    v_mfma_f32_16x16x32_bf16 v[124:127], v[52:55], v[20:23], v[124:127]
    s_waitcnt lgkmcnt(0)
    s_barrier
    v_mfma_f32_16x16x32_bf16 v[80:83], v[56:59], v[24:27], v[80:83]
    v_add_u32 v8, 0x00007280, v8
    v_add_u32 v10, 0x00007280, v10
    v_mfma_f32_16x16x32_bf16 v[84:87], v[56:59], v[28:31], v[84:87]
    v_add_u32 v12, 0x00007280, v12
    ds_read_b128 v[16:19], v8 offset:0
    v_mfma_f32_16x16x32_bf16 v[88:91], v[60:63], v[24:27], v[88:91]
    ds_read_b64_tr_b16 v[32:33], v10 offset:0
    ds_read_b64_tr_b16 v[34:35], v10 offset:768
    v_mfma_f32_16x16x32_bf16 v[92:95], v[60:63], v[28:31], v[92:95]
    ds_read_b128 v[20:23], v8 offset:2048
    ds_read_b64_tr_b16 v[36:37], v10 offset:32
    v_mfma_f32_16x16x32_bf16 v[96:99], v[64:67], v[24:27], v[96:99]
    ds_read_b64_tr_b16 v[38:39], v10 offset:800
    ds_read_b64_tr_b16 v[40:41], v10 offset:64
    v_mfma_f32_16x16x32_bf16 v[100:103], v[64:67], v[28:31], v[100:103]
    ds_read_b64_tr_b16 v[42:43], v10 offset:832
    ds_read_b64_tr_b16 v[44:45], v10 offset:96
    v_mfma_f32_16x16x32_bf16 v[104:107], v[68:71], v[24:27], v[104:107]
    ds_read_b64_tr_b16 v[46:47], v10 offset:864
    ds_read_b64_tr_b16 v[48:49], v10 offset:128
    v_mfma_f32_16x16x32_bf16 v[108:111], v[68:71], v[28:31], v[108:111]
    ds_read_b64_tr_b16 v[50:51], v10 offset:896
    ds_read_b64_tr_b16 v[52:53], v10 offset:160
    v_mfma_f32_16x16x32_bf16 v[112:115], v[72:75], v[24:27], v[112:115]
    ds_read_b64_tr_b16 v[54:55], v10 offset:928
    v_add_u32 v9, 0x00007280, v9
    v_mfma_f32_16x16x32_bf16 v[116:119], v[72:75], v[28:31], v[116:119]
    v_mfma_f32_16x16x32_bf16 v[120:123], v[76:79], v[24:27], v[120:123]
    v_mfma_f32_16x16x32_bf16 v[124:127], v[76:79], v[28:31], v[124:127]
    s_waitcnt lgkmcnt(0)
    v_mfma_f32_16x16x32_bf16 v[80:83], v[32:35], v[16:19], v[80:83]
    ds_read_b128 v[24:27], v9 offset:0
    ds_read_b64_tr_b16 v[56:57], v10 offset:6208
    v_mfma_f32_16x16x32_bf16 v[84:87], v[32:35], v[20:23], v[84:87]
    ds_read_b64_tr_b16 v[58:59], v10 offset:6976
    ds_read_b128 v[28:31], v9 offset:2048
    v_mfma_f32_16x16x32_bf16 v[88:91], v[36:39], v[16:19], v[88:91]
    ds_read_b64_tr_b16 v[60:61], v10 offset:6240
    ds_read_b64_tr_b16 v[62:63], v10 offset:7008
    v_mfma_f32_16x16x32_bf16 v[92:95], v[36:39], v[20:23], v[92:95]
    ds_read_b64_tr_b16 v[64:65], v10 offset:6272
    ds_read_b64_tr_b16 v[66:67], v10 offset:7040
    v_mfma_f32_16x16x32_bf16 v[96:99], v[40:43], v[16:19], v[96:99]
    ds_read_b64_tr_b16 v[68:69], v10 offset:6304
    ds_read_b64_tr_b16 v[70:71], v10 offset:7072
    v_mfma_f32_16x16x32_bf16 v[100:103], v[40:43], v[20:23], v[100:103]
    ds_read_b64_tr_b16 v[72:73], v10 offset:6336
    ds_read_b64_tr_b16 v[74:75], v10 offset:7104
    v_mfma_f32_16x16x32_bf16 v[104:107], v[44:47], v[16:19], v[104:107]
    ds_read_b64_tr_b16 v[76:77], v10 offset:6368
    ds_read_b64_tr_b16 v[78:79], v10 offset:7136
    v_mfma_f32_16x16x32_bf16 v[108:111], v[44:47], v[20:23], v[108:111]
    v_mfma_f32_16x16x32_bf16 v[112:115], v[48:51], v[16:19], v[112:115]
    v_mfma_f32_16x16x32_bf16 v[116:119], v[48:51], v[20:23], v[116:119]
    v_mfma_f32_16x16x32_bf16 v[120:123], v[52:55], v[16:19], v[120:123]
    v_mfma_f32_16x16x32_bf16 v[124:127], v[52:55], v[20:23], v[124:127]
    s_waitcnt lgkmcnt(0)
    s_barrier
    v_mfma_f32_16x16x32_bf16 v[80:83], v[56:59], v[24:27], v[80:83]
    v_add_u32 v8, 0xfffea880, v8
    v_add_u32 v10, 0xfffea880, v10
    v_mfma_f32_16x16x32_bf16 v[84:87], v[56:59], v[28:31], v[84:87]
    v_add_u32 v12, 0xfffea880, v12
    ds_read_b32 v16, v12 offset:0
    v_mfma_f32_16x16x32_bf16 v[88:91], v[60:63], v[24:27], v[88:91]
    ds_read_b32 v17, v12 offset:512
    ds_read_b32 v18, v12 offset:1056
    v_mfma_f32_16x16x32_bf16 v[92:95], v[60:63], v[28:31], v[92:95]
    ds_read_b32 v19, v12 offset:1568
    ds_read_b64_tr_b16 v[32:33], v10 offset:0
    v_mfma_f32_16x16x32_bf16 v[96:99], v[64:67], v[24:27], v[96:99]
    ds_read_b64_tr_b16 v[34:35], v10 offset:768
    ds_read_b32 v20, v12 offset:64
    v_mfma_f32_16x16x32_bf16 v[100:103], v[64:67], v[28:31], v[100:103]
    ds_read_b32 v21, v12 offset:576
    ds_read_b32 v22, v12 offset:1120
    v_mfma_f32_16x16x32_bf16 v[104:107], v[68:71], v[24:27], v[104:107]
    ds_read_b32 v23, v12 offset:1632
    ds_read_b64_tr_b16 v[36:37], v10 offset:32
    v_mfma_f32_16x16x32_bf16 v[108:111], v[68:71], v[28:31], v[108:111]
    ds_read_b64_tr_b16 v[38:39], v10 offset:800
    ds_read_b64_tr_b16 v[40:41], v10 offset:64
    v_mfma_f32_16x16x32_bf16 v[112:115], v[72:75], v[24:27], v[112:115]
    ds_read_b64_tr_b16 v[42:43], v10 offset:832
    ds_read_b64_tr_b16 v[44:45], v10 offset:96
    v_mfma_f32_16x16x32_bf16 v[116:119], v[72:75], v[28:31], v[116:119]
    ds_read_b64_tr_b16 v[46:47], v10 offset:864
    ds_read_b64_tr_b16 v[48:49], v10 offset:128
    v_mfma_f32_16x16x32_bf16 v[120:123], v[76:79], v[24:27], v[120:123]
    ds_read_b64_tr_b16 v[50:51], v10 offset:896
    ds_read_b64_tr_b16 v[52:53], v10 offset:160
    v_mfma_f32_16x16x32_bf16 v[124:127], v[76:79], v[28:31], v[124:127]
    ds_read_b64_tr_b16 v[54:55], v10 offset:928
    v_add_u32 v9, 0xfffea880, v9
    s_waitcnt lgkmcnt(0)
    v_mfma_f32_16x16x32_bf16 v[80:83], v[32:35], v[16:19], v[80:83]
    ds_read_b32 v24, v12 offset:8448
    ds_read_b32 v25, v12 offset:8960
    v_mfma_f32_16x16x32_bf16 v[84:87], v[32:35], v[20:23], v[84:87]
    ds_read_b32 v26, v12 offset:9504
    ds_read_b32 v27, v12 offset:10016
    v_mfma_f32_16x16x32_bf16 v[88:91], v[36:39], v[16:19], v[88:91]
    ds_read_b64_tr_b16 v[56:57], v10 offset:6208
    ds_read_b64_tr_b16 v[58:59], v10 offset:6976
    v_mfma_f32_16x16x32_bf16 v[92:95], v[36:39], v[20:23], v[92:95]
    ds_read_b32 v28, v12 offset:8512
    ds_read_b32 v29, v12 offset:9024
    v_mfma_f32_16x16x32_bf16 v[96:99], v[40:43], v[16:19], v[96:99]
    ds_read_b32 v30, v12 offset:9568
    ds_read_b32 v31, v12 offset:10080
    v_mfma_f32_16x16x32_bf16 v[100:103], v[40:43], v[20:23], v[100:103]
    ds_read_b64_tr_b16 v[60:61], v10 offset:6240
    ds_read_b64_tr_b16 v[62:63], v10 offset:7008
    v_mfma_f32_16x16x32_bf16 v[104:107], v[44:47], v[16:19], v[104:107]
    ds_read_b64_tr_b16 v[64:65], v10 offset:6272
    ds_read_b64_tr_b16 v[66:67], v10 offset:7040
    v_mfma_f32_16x16x32_bf16 v[108:111], v[44:47], v[20:23], v[108:111]
    ds_read_b64_tr_b16 v[68:69], v10 offset:6304
    ds_read_b64_tr_b16 v[70:71], v10 offset:7072
    v_mfma_f32_16x16x32_bf16 v[112:115], v[48:51], v[16:19], v[112:115]
    ds_read_b64_tr_b16 v[72:73], v10 offset:6336
    ds_read_b64_tr_b16 v[74:75], v10 offset:7104
    v_mfma_f32_16x16x32_bf16 v[116:119], v[48:51], v[20:23], v[116:119]
    ds_read_b64_tr_b16 v[76:77], v10 offset:6368
    ds_read_b64_tr_b16 v[78:79], v10 offset:7136
    v_mfma_f32_16x16x32_bf16 v[120:123], v[52:55], v[16:19], v[120:123]
    v_mfma_f32_16x16x32_bf16 v[124:127], v[52:55], v[20:23], v[124:127]
    s_waitcnt lgkmcnt(0)
    v_mfma_f32_16x16x32_bf16 v[80:83], v[56:59], v[24:27], v[80:83]
    v_mfma_f32_16x16x32_bf16 v[84:87], v[56:59], v[28:31], v[84:87]
    v_mfma_f32_16x16x32_bf16 v[88:91], v[60:63], v[24:27], v[88:91]
    v_mfma_f32_16x16x32_bf16 v[92:95], v[60:63], v[28:31], v[92:95]
    v_mfma_f32_16x16x32_bf16 v[96:99], v[64:67], v[24:27], v[96:99]
    v_mfma_f32_16x16x32_bf16 v[100:103], v[64:67], v[28:31], v[100:103]
    v_mfma_f32_16x16x32_bf16 v[104:107], v[68:71], v[24:27], v[104:107]
    v_mfma_f32_16x16x32_bf16 v[108:111], v[68:71], v[28:31], v[108:111]
    v_mfma_f32_16x16x32_bf16 v[112:115], v[72:75], v[24:27], v[112:115]
    v_mfma_f32_16x16x32_bf16 v[116:119], v[72:75], v[28:31], v[116:119]
    v_mfma_f32_16x16x32_bf16 v[120:123], v[76:79], v[24:27], v[120:123]
    v_mfma_f32_16x16x32_bf16 v[124:127], v[76:79], v[28:31], v[124:127]
    s_nop 7
    v_cvt_pk_bf16_f32 v80, v80, v81
    v_cvt_pk_bf16_f32 v81, v82, v83
    v_cvt_pk_bf16_f32 v82, v88, v89
    v_cvt_pk_bf16_f32 v83, v90, v91
    s_add_u32 s3, s22, 0
    s_nop 0
    v_permlane32_swap_b32 v80, v82
    v_permlane32_swap_b32 v81, v83
    s_nop 0
    v_permlane16_swap_b32 v80, v82
    v_permlane16_swap_b32 v81, v83
    buffer_store_dwordx4 v[80:83], v11, s[12:15], s3 offen sc1
    v_cvt_pk_bf16_f32 v84, v84, v85
    v_cvt_pk_bf16_f32 v85, v86, v87
    v_cvt_pk_bf16_f32 v86, v92, v93
    v_cvt_pk_bf16_f32 v87, v94, v95
    s_add_u32 s3, s22, 36864
    s_nop 0
    v_permlane32_swap_b32 v84, v86
    v_permlane32_swap_b32 v85, v87
    s_nop 0
    v_permlane16_swap_b32 v84, v86
    v_permlane16_swap_b32 v85, v87
    buffer_store_dwordx4 v[84:87], v11, s[12:15], s3 offen sc1
    v_cvt_pk_bf16_f32 v96, v96, v97
    v_cvt_pk_bf16_f32 v97, v98, v99
    v_cvt_pk_bf16_f32 v98, v104, v105
    v_cvt_pk_bf16_f32 v99, v106, v107
    s_add_u32 s3, s22, 64
    s_nop 0
    v_permlane32_swap_b32 v96, v98
    v_permlane32_swap_b32 v97, v99
    s_nop 0
    v_permlane16_swap_b32 v96, v98
    v_permlane16_swap_b32 v97, v99
    buffer_store_dwordx4 v[96:99], v11, s[12:15], s3 offen sc1
    v_cvt_pk_bf16_f32 v100, v100, v101
    v_cvt_pk_bf16_f32 v101, v102, v103
    v_cvt_pk_bf16_f32 v102, v108, v109
    v_cvt_pk_bf16_f32 v103, v110, v111
    s_add_u32 s3, s22, 36928
    s_nop 0
    v_permlane32_swap_b32 v100, v102
    v_permlane32_swap_b32 v101, v103
    s_nop 0
    v_permlane16_swap_b32 v100, v102
    v_permlane16_swap_b32 v101, v103
    buffer_store_dwordx4 v[100:103], v11, s[12:15], s3 offen sc1
    v_cvt_pk_bf16_f32 v112, v112, v113
    v_cvt_pk_bf16_f32 v113, v114, v115
    v_cvt_pk_bf16_f32 v114, v120, v121
    v_cvt_pk_bf16_f32 v115, v122, v123
    s_add_u32 s3, s22, 128
    s_nop 0
    v_permlane32_swap_b32 v112, v114
    v_permlane32_swap_b32 v113, v115
    s_nop 0
    v_permlane16_swap_b32 v112, v114
    v_permlane16_swap_b32 v113, v115
    buffer_store_dwordx4 v[112:115], v11, s[12:15], s3 offen sc1
    v_cvt_pk_bf16_f32 v116, v116, v117
    v_cvt_pk_bf16_f32 v117, v118, v119
    v_cvt_pk_bf16_f32 v118, v124, v125
    v_cvt_pk_bf16_f32 v119, v126, v127
    s_add_u32 s3, s22, 36992
    s_nop 0
    v_permlane32_swap_b32 v116, v118
    v_permlane32_swap_b32 v117, v119
    s_nop 0
    v_permlane16_swap_b32 v116, v118
    v_permlane16_swap_b32 v117, v119
    buffer_store_dwordx4 v[116:119], v11, s[12:15], s3 offen sc1
    s_branch K3_FIN
K3_LOAD:
    s_sub_u32 s20, s19, 4
    v_lshrrev_b32 v3, 4, v2
    v_bfe_u32 v4, v2, 2, 2
    v_xor_b32 v4, v4, v3
    v_lshlrev_b32 v5, 16, v4
    v_lshl_add_u32 v5, v3, 6, v5
    v_and_b32 v4, 3, v2
    v_lshl_add_u32 v5, v4, 4, v5
    s_lshl_b32 s3, s20, 10
    v_add_u32 v8, s3, v5
    s_lshl_b32 s40, s17, 12
    s_lshl_b32 s41, s20, 12
    s_add_u32 m0, s41, 0
    s_nop 0
    buffer_load_dwordx4 v8, s[4:7], s40 offen lds
    v_lshrrev_b32 v3, 5, v2
    v_lshlrev_b32 v3, 13, v3
    v_and_b32 v4, 31, v2
    v_lshl_add_u32 v9, v4, 4, v3
    s_lshl_b32 s47, s17, 9
    s_lshl_b32 s3, s20, 16
    s_add_u32 s47, s47, s3
    s_add_u32 s47, s47, 2097152
    s_mul_i32 s48, s20, 4224
    s_lshr_b32 s3, s20, 1
    s_lshl_b32 s3, s3, 5
    s_and_b32 s21, s20, 1
    s_lshl_b32 s21, s21, 3
    s_add_u32 s21, s21, s3
    v_add_u32 v3, 0, v2
    v_mul_u32_u24 v4, 5462, v3
    v_lshrrev_b32 v4, 16, v4
    v_mul_u32_u24 v5, 12, v4
    v_sub_u32 v5, v3, v5
    v_lshrrev_b32 v6, 3, v4
    v_and_b32 v4, 7, v4
    v_lshl_add_u32 v4, v6, 4, v4
    v_add_u32 v4, s21, v4
    v_lshrrev_b32 v6, 4, v4
    v_lshl_add_u32 v7, v6, 1, v4
    v_mul_u32_u24 v7, 1152, v7
    v_lshl_add_u32 v10, v5, 4, v7
    v_lshrrev_b32 v6, 1, v4
    v_lshl_add_u32 v7, v6, 4, v4
    v_add_u32 v7, 16, v7
    v_mul_u32_u24 v7, 1152, v7
    v_lshl_add_u32 v13, v5, 4, v7
    v_add_u32 v3, 64, v2
    v_mul_u32_u24 v4, 5462, v3
    v_lshrrev_b32 v4, 16, v4
    v_mul_u32_u24 v5, 12, v4
    v_sub_u32 v5, v3, v5
    v_lshrrev_b32 v6, 3, v4
    v_and_b32 v4, 7, v4
    v_lshl_add_u32 v4, v6, 4, v4
    v_add_u32 v4, s21, v4
    v_lshrrev_b32 v6, 4, v4
    v_lshl_add_u32 v7, v6, 1, v4
    v_mul_u32_u24 v7, 1152, v7
    v_lshl_add_u32 v11, v5, 4, v7
    v_lshrrev_b32 v6, 1, v4
    v_lshl_add_u32 v7, v6, 4, v4
    v_add_u32 v7, 16, v7
    v_mul_u32_u24 v7, 1152, v7
    v_lshl_add_u32 v14, v5, 4, v7
    v_add_u32 v3, 128, v2
    v_mul_u32_u24 v4, 5462, v3
    v_lshrrev_b32 v4, 16, v4
    v_mul_u32_u24 v5, 12, v4
    v_sub_u32 v5, v3, v5
    v_lshrrev_b32 v6, 3, v4
    v_and_b32 v4, 7, v4
    v_lshl_add_u32 v4, v6, 4, v4
    v_add_u32 v4, s21, v4
    v_lshrrev_b32 v6, 4, v4
    v_lshl_add_u32 v7, v6, 1, v4
    v_mul_u32_u24 v7, 1152, v7
    v_lshl_add_u32 v12, v5, 4, v7
    v_lshrrev_b32 v6, 1, v4
    v_lshl_add_u32 v7, v6, 4, v4
    v_add_u32 v7, 16, v7
    v_mul_u32_u24 v7, 1152, v7
    v_lshl_add_u32 v15, v5, 4, v7
    s_mul_i32 s46, s18, 192
    s_mul_i32 s42, s20, 3104
    s_add_u32 s42, s42, 16896
    s_add_u32 m0, s41, 1024
    s_add_u32 s43, s40, 256
    buffer_load_dwordx4 v8, s[4:7], s43 offen lds
    s_add_u32 m0, s41, 2048
    s_add_u32 s43, s40, 512
    buffer_load_dwordx4 v8, s[4:7], s43 offen lds
    s_add_u32 m0, s41, 3072
    s_add_u32 s43, s40, 768
    buffer_load_dwordx4 v8, s[4:7], s43 offen lds
    s_add_u32 m0, s42, 0
    s_add_u32 s43, s46, 0
    buffer_load_dwordx4 v10, s[8:11], s43 offen lds
    s_add_u32 m0, s42, 1024
    s_add_u32 s43, s46, 0
    buffer_load_dwordx4 v11, s[8:11], s43 offen lds
    s_add_u32 m0, s42, 2048
    s_add_u32 s43, s46, 0
    buffer_load_dwordx4 v12, s[8:11], s43 offen lds
    s_add_u32 m0, s41, 29312
    s_add_u32 s43, s40, 262144
    buffer_load_dwordx4 v8, s[4:7], s43 offen lds
    s_add_u32 m0, s41, 30336
    s_add_u32 s43, s40, 262400
    buffer_load_dwordx4 v8, s[4:7], s43 offen lds
    s_add_u32 m0, s41, 31360
    s_add_u32 s43, s40, 262656
    buffer_load_dwordx4 v8, s[4:7], s43 offen lds
    s_add_u32 m0, s41, 32384
    s_add_u32 s43, s40, 262912
    buffer_load_dwordx4 v8, s[4:7], s43 offen lds
    s_add_u32 m0, s42, 29312
    s_add_u32 s43, s46, 82944
    buffer_load_dwordx4 v10, s[8:11], s43 offen lds
    s_add_u32 m0, s42, 30336
    s_add_u32 s43, s46, 82944
    buffer_load_dwordx4 v11, s[8:11], s43 offen lds
    s_add_u32 m0, s42, 31360
    s_add_u32 s43, s46, 82944
    buffer_load_dwordx4 v12, s[8:11], s43 offen lds
    s_waitcnt vmcnt(7)
    s_barrier
    s_add_u32 m0, s41, 58624
    s_add_u32 s43, s40, 524288
    buffer_load_dwordx4 v8, s[4:7], s43 offen lds
    s_add_u32 m0, s41, 59648
    s_add_u32 s43, s40, 524544
    buffer_load_dwordx4 v8, s[4:7], s43 offen lds
    s_add_u32 m0, s41, 60672
    s_add_u32 s43, s40, 524800
    buffer_load_dwordx4 v8, s[4:7], s43 offen lds
    s_add_u32 m0, s41, 61696
    s_add_u32 s43, s40, 525056
    buffer_load_dwordx4 v8, s[4:7], s43 offen lds
    s_add_u32 m0, s42, 58624
    s_add_u32 s43, s46, 165888
    buffer_load_dwordx4 v10, s[8:11], s43 offen lds
    s_add_u32 m0, s42, 59648
    s_add_u32 s43, s46, 165888
    buffer_load_dwordx4 v11, s[8:11], s43 offen lds
    s_add_u32 m0, s42, 60672
    s_add_u32 s43, s46, 165888
    buffer_load_dwordx4 v12, s[8:11], s43 offen lds
    s_waitcnt vmcnt(7)
    s_barrier
    s_add_u32 m0, s41, 87936
    s_add_u32 s43, s40, 786432
    buffer_load_dwordx4 v8, s[4:7], s43 offen lds
    s_add_u32 m0, s41, 88960
    s_add_u32 s43, s40, 786688
    buffer_load_dwordx4 v8, s[4:7], s43 offen lds
    s_add_u32 m0, s41, 89984
    s_add_u32 s43, s40, 786944
    buffer_load_dwordx4 v8, s[4:7], s43 offen lds
    s_add_u32 m0, s41, 91008
    s_add_u32 s43, s40, 787200
    buffer_load_dwordx4 v8, s[4:7], s43 offen lds
    s_add_u32 m0, s42, 87936
    s_add_u32 s43, s46, 248832
    buffer_load_dwordx4 v10, s[8:11], s43 offen lds
    s_add_u32 m0, s42, 88960
    s_add_u32 s43, s46, 248832
    buffer_load_dwordx4 v11, s[8:11], s43 offen lds
    s_add_u32 m0, s42, 89984
    s_add_u32 s43, s46, 248832
    buffer_load_dwordx4 v12, s[8:11], s43 offen lds
    s_waitcnt vmcnt(7)
    s_barrier
    s_add_u32 m0, s41, 0
    s_add_u32 s43, s40, 1048576
    buffer_load_dwordx4 v8, s[4:7], s43 offen lds
    s_add_u32 m0, s41, 1024
    s_add_u32 s43, s40, 1048832
    buffer_load_dwordx4 v8, s[4:7], s43 offen lds
    s_add_u32 m0, s41, 2048
    s_add_u32 s43, s40, 1049088
    buffer_load_dwordx4 v8, s[4:7], s43 offen lds
    s_add_u32 m0, s41, 3072
    s_add_u32 s43, s40, 1049344
    buffer_load_dwordx4 v8, s[4:7], s43 offen lds
    s_add_u32 m0, s42, 0
    s_add_u32 s43, s46, 331776
    buffer_load_dwordx4 v10, s[8:11], s43 offen lds
    s_add_u32 m0, s42, 1024
    s_add_u32 s43, s46, 331776
    buffer_load_dwordx4 v11, s[8:11], s43 offen lds
    s_add_u32 m0, s42, 2048
    s_add_u32 s43, s46, 331776
    buffer_load_dwordx4 v12, s[8:11], s43 offen lds
    s_waitcnt vmcnt(7)
    s_barrier
    s_add_u32 m0, s41, 29312
    s_add_u32 s43, s40, 1310720
    buffer_load_dwordx4 v8, s[4:7], s43 offen lds
    s_add_u32 m0, s41, 30336
    s_add_u32 s43, s40, 1310976
    buffer_load_dwordx4 v8, s[4:7], s43 offen lds
    s_add_u32 m0, s41, 31360
    s_add_u32 s43, s40, 1311232
    buffer_load_dwordx4 v8, s[4:7], s43 offen lds
    s_add_u32 m0, s41, 32384
    s_add_u32 s43, s40, 1311488
    buffer_load_dwordx4 v8, s[4:7], s43 offen lds
    s_add_u32 m0, s42, 29312
    s_add_u32 s43, s46, 414720
    buffer_load_dwordx4 v10, s[8:11], s43 offen lds
    s_add_u32 m0, s42, 30336
    s_add_u32 s43, s46, 414720
    buffer_load_dwordx4 v11, s[8:11], s43 offen lds
    s_add_u32 m0, s42, 31360
    s_add_u32 s43, s46, 414720
    buffer_load_dwordx4 v12, s[8:11], s43 offen lds
    s_waitcnt vmcnt(7)
    s_barrier
    s_add_u32 m0, s41, 58624
    s_add_u32 s43, s40, 1572864
    buffer_load_dwordx4 v8, s[4:7], s43 offen lds
    s_add_u32 m0, s41, 59648
    s_add_u32 s43, s40, 1573120
    buffer_load_dwordx4 v8, s[4:7], s43 offen lds
    s_add_u32 m0, s41, 60672
    s_add_u32 s43, s40, 1573376
    buffer_load_dwordx4 v8, s[4:7], s43 offen lds
    s_add_u32 m0, s41, 61696
    s_add_u32 s43, s40, 1573632
    buffer_load_dwordx4 v8, s[4:7], s43 offen lds
    s_add_u32 m0, s42, 58624
    s_add_u32 s43, s46, 497664
    buffer_load_dwordx4 v10, s[8:11], s43 offen lds
    s_add_u32 m0, s42, 59648
    s_add_u32 s43, s46, 497664
    buffer_load_dwordx4 v11, s[8:11], s43 offen lds
    s_add_u32 m0, s42, 60672
    s_add_u32 s43, s46, 497664
    buffer_load_dwordx4 v12, s[8:11], s43 offen lds
    s_waitcnt vmcnt(7)
    s_barrier
    s_add_u32 m0, s41, 87936
    s_add_u32 s43, s40, 1835008
    buffer_load_dwordx4 v8, s[4:7], s43 offen lds
    s_add_u32 m0, s41, 88960
    s_add_u32 s43, s40, 1835264
    buffer_load_dwordx4 v8, s[4:7], s43 offen lds
    s_add_u32 m0, s41, 89984
    s_add_u32 s43, s40, 1835520
    buffer_load_dwordx4 v8, s[4:7], s43 offen lds
    s_add_u32 m0, s41, 91008
    s_add_u32 s43, s40, 1835776
    buffer_load_dwordx4 v8, s[4:7], s43 offen lds
    s_add_u32 m0, s42, 87936
    s_add_u32 s43, s46, 580608
    buffer_load_dwordx4 v10, s[8:11], s43 offen lds
    s_add_u32 m0, s42, 88960
    s_add_u32 s43, s46, 580608
    buffer_load_dwordx4 v11, s[8:11], s43 offen lds
    s_add_u32 m0, s42, 89984
    s_add_u32 s43, s46, 580608
    buffer_load_dwordx4 v12, s[8:11], s43 offen lds
    s_waitcnt vmcnt(7)
    s_barrier
    s_add_u32 m0, s48, 0
    s_add_u32 s43, s47, 0
    buffer_load_dwordx4 v9, s[4:7], s43 offen lds
    s_add_u32 m0, s48, 1056
    s_add_u32 s43, s47, 16384
    buffer_load_dwordx4 v9, s[4:7], s43 offen lds
    s_add_u32 m0, s48, 2112
    s_add_u32 s43, s47, 32768
    buffer_load_dwordx4 v9, s[4:7], s43 offen lds
    s_add_u32 m0, s48, 3168
    s_add_u32 s43, s47, 49152
    buffer_load_dwordx4 v9, s[4:7], s43 offen lds
    s_add_u32 m0, s42, 0
    s_add_u32 s43, s46, 0
    buffer_load_dwordx4 v13, s[8:11], s43 offen lds
    s_add_u32 m0, s42, 1024
    s_add_u32 s43, s46, 0
    buffer_load_dwordx4 v14, s[8:11], s43 offen lds
    s_add_u32 m0, s42, 2048
    s_add_u32 s43, s46, 0
    buffer_load_dwordx4 v15, s[8:11], s43 offen lds
    s_waitcnt vmcnt(7)
    s_barrier
    s_waitcnt vmcnt(0)
    s_barrier
K3_FIN:
K3_END:
    s_endpgm
.section .rodata,"a"
.p2align 6
.amdhsa_kernel qkv_kernel
  .amdhsa_next_free_vgpr 180
  .amdhsa_next_free_sgpr 96
  .amdhsa_accum_offset 180
  .amdhsa_group_segment_fixed_size 0
  .amdhsa_kernarg_size 72
  .amdhsa_user_sgpr_count 2
  .amdhsa_user_sgpr_kernarg_segment_ptr 1
  .amdhsa_system_sgpr_workgroup_id_x 1
.end_amdhsa_kernel
.p2align 6
.amdhsa_kernel attn_kernel
  .amdhsa_next_free_vgpr 212
  .amdhsa_next_free_sgpr 96
  .amdhsa_accum_offset 212
  .amdhsa_group_segment_fixed_size 0
  .amdhsa_kernarg_size 72
  .amdhsa_user_sgpr_count 2
  .amdhsa_user_sgpr_kernarg_segment_ptr 1
  .amdhsa_system_sgpr_workgroup_id_x 1
.end_amdhsa_kernel
.p2align 6
.amdhsa_kernel proj_kernel
  .amdhsa_next_free_vgpr 128
  .amdhsa_next_free_sgpr 96
  .amdhsa_accum_offset 128
  .amdhsa_group_segment_fixed_size 0
  .amdhsa_kernarg_size 72
  .amdhsa_user_sgpr_count 2
  .amdhsa_user_sgpr_kernarg_segment_ptr 1
  .amdhsa_system_sgpr_workgroup_id_x 1
.end_amdhsa_kernel
```
